```python
import torch

def _softmax(x, axis=-1):
    return torch.softmax(x, dim=axis)
def _gelu(x):
    return torch.nn.functional.gelu(x, approximate="tanh")
def _silu(x):
    return torch.nn.functional.silu(x)
def _sigmoid(x):
    return torch.sigmoid(x)
def _layernorm(x, axis=-1, eps=1e-5):
    m = x.mean(dim=axis, keepdim=True)
    v = x.var(dim=axis, keepdim=True, unbiased=False)
    return (x - m) / torch.sqrt(v + eps)
def _scatter_add(tgt, idx, src, axis=0):
    return tgt.clone().index_add_(axis, idx, src)
def _segment_sum(src, seg, n):
    out = torch.zeros((n,) + src.shape[1:], dtype=src.dtype)
    return out.index_add_(0, seg, src)
def _pad(x, pw):
    flat = tuple(v for pair in reversed(pw) for v in pair)
    return torch.nn.functional.pad(x, flat)

kernel_name = 'parallel_sum__ssm_conv_s4__moe_arch_mod__prompt'

def setup_inputs():

    _w = (lambda a: (lambda t: t.to(torch.bfloat16) if t.is_floating_point() else t)(torch.as_tensor(a)))
    def _A_setup():
        B, L, D, N = 1, 2048, 512, 128
        A_re = -(lambda _x: torch.exp(torch.as_tensor(_x)))((lambda *s: torch.randn(*s, dtype=torch.bfloat16) * 3.2)(D, N))
        A_im = torch.pi * (lambda *s: torch.randn(*s, dtype=torch.bfloat16) * 0.1)(D, N)
        B_re = (lambda *s: torch.randn(*s, dtype=torch.bfloat16) * 0.4)(D, N)
        B_im = (lambda *s: torch.randn(*s, dtype=torch.bfloat16) * 0.4)(D, N)
        C_re = (lambda *s: torch.randn(*s, dtype=torch.bfloat16) * 0.4)(D, N)
        C_im = (lambda *s: torch.randn(*s, dtype=torch.bfloat16) * 0.4)(D, N)
        log_dt = (lambda *s: torch.randn(*s, dtype=torch.bfloat16) * 0.1)(D) * 0.5 - 4.0
        Dskip = (lambda *s: torch.randn(*s, dtype=torch.bfloat16) * 0.1)(D)
        return {
            "u": _w((lambda *s: torch.randn(*s, dtype=torch.bfloat16) * 0.05)(B, L, D)),
            "A_re": _w(A_re),
            "A_im": _w(A_im),
            "B_re": _w(B_re),
            "B_im": _w(B_im),
            "C_re": _w(C_re),
            "C_im": _w(C_im),
            "log_dt": _w(log_dt),
            "Dskip": _w(Dskip),
        }
    _A_in = _A_setup()

    def _B_setup():
        B, S, D, F, C = 1, 2048, 512, 1792, 2
        return {
            "x": _w((lambda *s: torch.randn(*s, dtype=torch.bfloat16) * 0.05)(B, S, D)),
            "w_r": _w((lambda *s: torch.randn(*s, dtype=torch.bfloat16) * 0.05)(D)),
            "w_gate": _w((lambda *s: torch.randn(*s, dtype=torch.bfloat16) * 0.05)(D, F)),
            "w_up": _w((lambda *s: torch.randn(*s, dtype=torch.bfloat16) * 0.05)(D, F)),
            "w_down": _w((lambda *s: torch.randn(*s, dtype=torch.bfloat16) * 0.05)(F, D)),
        }
    _B_in = _B_setup()

    return {
        "A_u": _A_in["u"],
        "A_A_re": _A_in["A_re"],
        "A_A_im": _A_in["A_im"],
        "A_B_re": _A_in["B_re"],
        "A_B_im": _A_in["B_im"],
        "A_C_re": _A_in["C_re"],
        "A_C_im": _A_in["C_im"],
        "A_log_dt": _A_in["log_dt"],
        "A_Dskip": _A_in["Dskip"],
        "B_x": _B_in["x"],
        "B_w_r": _B_in["w_r"],
        "B_w_gate": _B_in["w_gate"],
        "B_w_up": _B_in["w_up"],
        "B_w_down": _B_in["w_down"],
    }

def reference(A_u, A_A_re, A_A_im, A_B_re, A_B_im, A_C_re, A_C_im, A_log_dt, A_Dskip, B_x, B_w_r, B_w_gate, B_w_up, B_w_down):
    def _A_ref(u, A_re, A_im, B_re, B_im, C_re, C_im, log_dt, Dskip):
        Bsz, L, D = u.shape
        dt = torch.exp(log_dt)[:, None]
        A = A_re + 1j * A_im
        Bc = B_re + 1j * B_im
        Cc = C_re + 1j * C_im
        logdA = dt * A
        dB = dt * Bc
        l = (lambda x, dt: x.to(dt))(torch.arange(L), A_re.dtype)
        P = torch.exp(logdA[:, :, None] * l[None, None, :])
        K = torch.einsum("dn,dnl,dn->dl", Cc, P, dB).real
        L2 = 2 * L
        Kp = _pad(K, ((0, 0), (0, L)))
        up = (lambda x, *d: x.permute(*d))(u, 0, 2, 1)
        up = _pad(up, ((0, 0), (0, 0), (0, L)))
        Kf = (lambda x, axes=(-2,-1): torch.fft.rfft2(x.float(), dim=axes))(Kp[:, None, :], axes=(-2, -1))
        Uf = (lambda x, axes=(-2,-1): torch.fft.rfft2(x.float(), dim=axes))(up[:, :, None, :], axes=(-2, -1))
        Yf = Uf * Kf[None, :, :, :]
        y = (lambda x, s, axes=(-2,-1): torch.fft.irfft2(x, s=s, dim=axes).to(torch.bfloat16))(Yf, (1, L2), axes=(-2, -1))[:, :, 0, :L]
        y = (lambda x, *d: x.permute(*d))(y, 0, 2, 1) + u * Dskip[None, None, :]
        return y

    def _B_ref(x, w_r, w_gate, w_up, w_down):
        B, S, D = x.shape
        C = 2
        r = x @ w_r
        idx = torch.argsort(-r, axis=-1)[:, :C]
        idx_e = (lambda x, n, axis: torch.repeat_interleave(x, n, dim=axis))(idx.reshape(B, C, 1), D, axis=2)
        x_sel = (lambda x, i, axis: torch.take_along_dim(x, i, dim=axis))(x, idx_e, axis=1)
        g = _silu(x_sel @ w_gate)
        u = x_sel @ w_up
        y = (g * u) @ w_down
        r_sel = _sigmoid((lambda x, i, axis: torch.take_along_dim(x, i, dim=axis))(r, idx, axis=1))
        y = y * r_sel.reshape(B, C, 1)
        b_off = (torch.arange(B) * S).reshape(B, 1)
        flat_idx = (idx + b_off).reshape(B * C)
        zero = (x * 0.0).reshape(B * S, D)
        upd = _scatter_add(zero, flat_idx, y.reshape(B * C, D), axis=0)
        return x + upd.reshape(B, S, D)

    x = A_u
    xn = _layernorm(x, axis=-1)
    return x + _A_ref(xn, A_A_re, A_A_im, A_B_re, A_B_im, A_C_re, A_C_im, A_log_dt, A_Dskip) + _B_ref(xn, B_w_r, B_w_gate, B_w_up, B_w_down)
```

```asm
; @launch grid=(256,1,1) block=(768,1,1) lds=133056
.amdgcn_target "amdgcn-amd-amdhsa--gfx950"
.text
.globl parallel_sum__ssm_conv_s4__moe_arch_mod__prompt_kernel
.p2align 8
.type parallel_sum__ssm_conv_s4__moe_arch_mod__prompt_kernel,@function
parallel_sum__ssm_conv_s4__moe_arch_mod__prompt_kernel:
    s_cmp_ge_u32 s2, 256
    s_cbranch_scc1 L_END
    s_getpc_b64 s[100:101]
    v_lshrrev_b32 v2, 6, v0
    v_and_b32 v1, 63, v0
    v_readfirstlane_b32 s3, v2
    s_cmp_lg_u32 s3, 11
    s_cbranch_scc1 L_NOPF
    v_lshlrev_b32 v12, 7, v1
    global_load_dword v14, v12, s[100:101]
    v_add_u32 v12, 0x2000, v12
    v_min_u32 v17, 17204, v12
    global_load_dword v15, v17, s[100:101]
    v_add_u32 v12, 0x2000, v12
    v_min_u32 v12, 17204, v12
    global_load_dword v16, v12, s[100:101]
    v_mov_b32 v8, 0
    v_mov_b32 v9, 0
    v_mov_b32 v10, 0
    v_mov_b32 v11, 0
    v_mov_b32 v13, 124512
    ds_write_b128 v13, v[8:11]
    ds_write_b128 v13, v[8:11] offset:16
    ds_write_b128 v13, v[8:11] offset:32
    ds_write_b128 v13, v[8:11] offset:48
    ds_write_b128 v13, v[8:11] offset:64
    s_waitcnt lgkmcnt(0)
L_NOPF:
    s_load_dwordx16 s[16:31], s[0:1], 0
    s_load_dwordx16 s[32:47], s[0:1], 64
    s_load_dwordx2 s[48:49], s[0:1], 128
    s_getreg_b32 s99, hwreg(HW_REG_XCC_ID)
    s_and_b32 s5, s2, 7
    s_lshr_b32 s6, s2, 3
    s_lshl_b32 s4, s5, 5
    s_add_u32 s4, s4, s6
    s_lshl_b32 s11, s4, 2
    s_bfe_u32 s7, s3, 0x10001
    s_and_b32 s13, s3, 1
    s_lshl_b32 s8, s4, 1
    s_add_u32 s8, s8, s7
    s_lshl_b32 s9, s8, 8
    v_lshlrev_b32 v5, 2, v1
    v_add_u32 v5, s9, v5
    s_and_b32 s99, s99, 15
    s_barrier
    s_cmp_ge_u32 s3, 8
    s_cbranch_scc1 L_MW
    s_cmp_ge_u32 s3, 4
    s_cbranch_scc1 L_BW
    s_setprio 3
    v_and_b32 v6, 31, v1
    v_lshlrev_b32 v6, 4, v6
    v_lshrrev_b32 v7, 5, v1
    s_lshl_b32 s12, s2, 3
    s_lshl_b32 s14, s3, 1
    s_add_u32 s12, s12, s14
    v_add_u32 v7, s12, v7
    v_lshl_add_u32 v7, v7, 10, v6
    v_lshrrev_b32 v76, 7, v7
    v_and_b32 v76, 0xfffffff8, v76
    v_mov_b32 v134, 0
    v_mov_b32 v135, 0
    v_mov_b32 v136, 0
    v_mov_b32 v78, 0
    s_waitcnt lgkmcnt(0)
    global_load_dwordx4 v[8:11], v7, s[16:17]
    global_load_dwordx4 v[12:15], v7, s[16:17] offset:512
    global_load_dwordx4 v[16:19], v6, s[36:37]
    global_load_dwordx4 v[20:23], v6, s[36:37] offset:512
    s_load_dword s10, s[48:49], 196608
    s_load_dword s15, s[32:33], s11
    s_branch L_PRE
L_MW:
    s_setprio 3
    s_lshl_b32 s14, s4, 7
    s_add_u32 s14, s14, 163840
    v_mov_b32 v79, s14
    s_waitcnt lgkmcnt(0)
    global_load_dword v100, v5, s[18:19]
    global_load_dword v101, v5, s[20:21]
    global_load_dword v102, v5, s[22:23]
    global_load_dword v103, v5, s[24:25]
    global_load_dword v104, v5, s[26:27]
    global_load_dword v105, v5, s[28:29]
    global_load_dword v110, v79, s[48:49] sc1
    s_load_dword s56, s[30:31], s11
    s_setprio 0
    s_branch L_MOE
L_BW:
    v_and_b32 v76, 15, v1
    v_lshrrev_b32 v77, 4, v1
    s_and_b32 s12, s3, 3
    s_lshl_b32 s14, s6, 16
    s_lshl_b32 s15, s5, 7
    s_add_u32 s14, s14, s15
    s_lshl_b32 s15, s12, 5
    s_add_u32 s14, s14, s15
    v_lshrrev_b32 v78, 2, v1
    v_lshlrev_b32 v78, 12, v78
    v_and_b32 v79, 3, v1
    v_lshl_add_u32 v78, v79, 3, v78
    v_add_u32 v78, s14, v78
    v_lshl_add_u32 v133, v76, 2, v77
    v_lshlrev_b32 v133, 2, v133
    s_lshl_b32 s14, s5, 18
    s_lshl_b32 s50, s6, 8
    s_add_u32 s14, s14, s50
    s_lshl_b32 s50, s12, 16
    s_add_u32 s14, s14, s50
    s_add_u32 s14, s14, 1048576
    v_lshlrev_b32 v134, 14, v77
    v_lshl_add_u32 v134, v76, 4, v134
    v_add_u32 v134, s14, v134
    v_add_u32 v135, 0x2000, v134
    s_lshl_b32 s14, s4, 7
    s_lshl_b32 s50, s12, 5
    s_add_u32 s14, s14, s50
    s_add_u32 s14, s14, 131072
    v_lshl_add_u32 v136, v77, 3, s14
    s_waitcnt lgkmcnt(0)
    global_load_dword v80, v5, s[18:19]
    global_load_dword v81, v5, s[20:21]
    s_load_dword s15, s[32:33], s11
    s_load_dword s56, s[30:31], s11
    v_mov_b32 v8, 0
    v_mov_b32 v9, 0
    v_mov_b32 v10, 0
    v_mov_b32 v11, 0
    v_lshrrev_b32 v12, 5, v1
    v_mul_u32_u24 v12, 4608, v12
    v_and_b32 v13, 31, v1
    v_lshl_add_u32 v12, v13, 4, v12
    v_add_u32 v12, 73728, v12
    ds_write_b128 v12, v[8:11]
L_PRE:
    v_add_u32 v4, 256, v0
    v_and_b32 v4, 511, v4
    v_lshlrev_b32 v4, 2, v4
    v_lshlrev_b32 v3, 10, v4
    v_add_u32 v3, s11, v3
    v_lshlrev_b32 v115, 3, v4
    v_lshlrev_b32 v128, 1, v4
    v_add_u32 v128, 78880, v128
    s_lshl_b32 s50, s5, 12
    s_lshl_b32 s51, s6, 2
    s_add_u32 s50, s50, s51
    s_add_u32 s50, s50, 131072
    v_lshrrev_b32 v124, 6, v4
    v_lshl_add_u32 v124, v124, 7, s50
    s_lshl_b32 s50, s4, 13
    s_add_u32 s50, s50, 1048576
    v_lshl_add_u32 v126, v4, 2, s50
    v_and_b32 v24, 15, v1
    v_lshl_add_u32 v127, v24, 1, 1
    s_lshr_b32 s57, s3, 2
    s_mul_i32 s61, s57, 34816
    v_mul_u32_u24 v26, 544, v24
    v_lshrrev_b32 v25, 4, v1
    v_lshl_add_u32 v26, v25, 4, v26
    s_mul_i32 s60, s7, 8704
    s_add_u32 s60, s60, s61
    s_mul_i32 s62, s13, 8704
    s_add_u32 s62, s62, s61
    s_add_u32 s62, s62, 17408
    v_add_u32 v108, s60, v26
    v_add_u32 v109, s62, v26
    s_mov_b32 s50, 0
    s_mov_b32 s51, -1
    s_mul_i32 s60, s57, 4608
    s_lshl_b32 s58, s13, 8
    s_sub_u32 s60, s60, s58
    v_lshlrev_b32 v26, 4, v24
    s_cmp_eq_u32 s7, 0
    s_cbranch_scc0 L_TA1
    s_add_u32 s60, s60, 73720
    v_and_b32 v27, 1, v25
    v_lshl_add_u32 v26, v27, 3, v26
    v_lshrrev_b32 v27, 1, v25
    v_lshl_add_u32 v26, v27, 9, v26
    v_sub_u32 v110, s60, v26
    v_mov_b32 v100, 0x05040706
    v_mov_b32 v27, 0x03020504
    v_cndmask_b32 v100, v100, v27, s[50:51]
    v_mov_b32 v101, 0x01000302
    v_mov_b32 v27, 0x01000100
    v_cndmask_b32 v101, v101, v27, s[50:51]
    s_branch L_TAD
L_TA1:
    s_add_u32 s60, s60, 72688
    v_lshlrev_b32 v27, 9, v25
    v_cmp_eq_u32 vcc, 3, v25
    v_add_u32 v28, 512, v27
    s_nop 0
    v_cndmask_b32 v27, v27, v28, vcc
    v_add_u32 v26, v26, v27
    v_sub_u32 v110, s60, v26
    v_subrev_u32 v111, 512, v110
    v_mov_b32 v100, 0x05040504
    v_mov_b32 v101, 0x03020302
    v_cndmask_b32 v100, v100, v101, s[50:51]
    v_mov_b32 v102, 0x01000302
    v_mov_b32 v103, 0x01000100
    s_mov_b32 s52, 0
    s_mov_b32 s53, 0x55555555
    v_cndmask_b32 v101, v101, v102, s[52:53]
    v_cndmask_b32 v102, v102, v103, s[50:51]
L_TAD:
    s_cmp_ge_u32 s3, 4
    s_cbranch_scc1 L_BTASK
    s_mov_b32 s50, 0
    s_mov_b32 s51, -1
    s_mov_b32 s55, 0xffff
    v_mov_b32 v28, 0x3b000000
    v_mov_b32 v29, 124480
    v_mov_b32 v30, 124516
    v_mov_b32 v31, 1
    s_waitcnt vmcnt(2)
    v_lshlrev_b32 v32, 16, v8
    v_and_b32 v33, 0xffff0000, v8
    v_lshlrev_b32 v34, 16, v9
    v_and_b32 v35, 0xffff0000, v9
    v_lshlrev_b32 v36, 16, v10
    v_and_b32 v37, 0xffff0000, v10
    v_lshlrev_b32 v38, 16, v11
    v_and_b32 v39, 0xffff0000, v11
    v_lshlrev_b32 v40, 16, v12
    v_and_b32 v41, 0xffff0000, v12
    v_lshlrev_b32 v42, 16, v13
    v_and_b32 v43, 0xffff0000, v13
    v_lshlrev_b32 v44, 16, v14
    v_and_b32 v45, 0xffff0000, v14
    v_lshlrev_b32 v46, 16, v15
    v_and_b32 v47, 0xffff0000, v15
    v_readlane_b32 s52, v32, 0
    v_readlane_b32 s53, v32, 32
    v_pk_add_f32 v[64:65], v[32:33], v[34:35]
    v_pk_add_f32 v[66:67], v[36:37], v[38:39]
    v_mov_b32 v24, s52
    v_mov_b32 v25, s53
    v_pk_add_f32 v[68:69], v[40:41], v[42:43]
    v_cndmask_b32 v24, v24, v25, s[50:51]
    v_pk_add_f32 v[70:71], v[44:45], v[46:47]
    v_mov_b32 v25, v24
    v_pk_add_f32 v[64:65], v[64:65], v[66:67]
    v_pk_add_f32 v[68:69], v[68:69], v[70:71]
    v_pk_add_f32 v[48:49], v[32:33], v[24:25] neg_lo:[0,1] neg_hi:[0,1]
    v_pk_add_f32 v[50:51], v[34:35], v[24:25] neg_lo:[0,1] neg_hi:[0,1]
    v_pk_add_f32 v[52:53], v[36:37], v[24:25] neg_lo:[0,1] neg_hi:[0,1]
    v_pk_add_f32 v[54:55], v[38:39], v[24:25] neg_lo:[0,1] neg_hi:[0,1]
    v_pk_add_f32 v[56:57], v[40:41], v[24:25] neg_lo:[0,1] neg_hi:[0,1]
    v_pk_add_f32 v[58:59], v[42:43], v[24:25] neg_lo:[0,1] neg_hi:[0,1]
    v_pk_add_f32 v[60:61], v[44:45], v[24:25] neg_lo:[0,1] neg_hi:[0,1]
    v_pk_add_f32 v[62:63], v[46:47], v[24:25] neg_lo:[0,1] neg_hi:[0,1]
    v_pk_add_f32 v[64:65], v[64:65], v[68:69]
    v_pk_mul_f32 v[72:73], v[48:49], v[48:49]
    v_pk_mul_f32 v[74:75], v[50:51], v[50:51]
    v_add_f32 v64, v64, v65
    v_pk_fma_f32 v[72:73], v[52:53], v[52:53], v[72:73]
    v_pk_fma_f32 v[74:75], v[54:55], v[54:55], v[74:75]
    v_pk_fma_f32 v[72:73], v[56:57], v[56:57], v[72:73]
    v_pk_fma_f32 v[74:75], v[58:59], v[58:59], v[74:75]
    v_pk_fma_f32 v[72:73], v[60:61], v[60:61], v[72:73]
    v_pk_fma_f32 v[74:75], v[62:63], v[62:63], v[74:75]
    v_pk_add_f32 v[72:73], v[72:73], v[74:75]
    v_add_f32 v72, v72, v73
    v_add_f32_dpp v64, v64, v64 quad_perm:[1,0,3,2] row_mask:0xf bank_mask:0xf
    s_nop 0
    v_add_f32_dpp v72, v72, v72 quad_perm:[1,0,3,2] row_mask:0xf bank_mask:0xf
    v_add_f32_dpp v64, v64, v64 quad_perm:[2,3,0,1] row_mask:0xf bank_mask:0xf
    s_nop 0
    v_add_f32_dpp v72, v72, v72 quad_perm:[2,3,0,1] row_mask:0xf bank_mask:0xf
    v_add_f32_dpp v64, v64, v64 row_half_mirror row_mask:0xf bank_mask:0xf
    s_nop 0
    v_add_f32_dpp v72, v72, v72 row_half_mirror row_mask:0xf bank_mask:0xf
    v_add_f32_dpp v64, v64, v64 row_mirror row_mask:0xf bank_mask:0xf
    s_nop 0
    v_add_f32_dpp v72, v72, v72 row_mirror row_mask:0xf bank_mask:0xf
    v_mov_b32 v65, v64
    v_mov_b32 v73, v72
    s_nop 0
    v_permlane16_swap_b32 v64, v65
    v_permlane16_swap_b32 v72, v73
    v_add_f32 v64, v64, v65
    v_add_f32 v72, v72, v73
    v_mul_f32 v64, v64, v28
    v_mul_f32 v72, v72, v28
    v_sub_f32 v65, v64, v24
    v_fma_f32 v72, -v65, v65, v72
    v_max_f32 v72, 0, v72
    v_cvt_pk_bf16_f32 v64, v64, v72
    v_and_b32 v72, 0xffff0000, v64
    v_lshlrev_b32 v66, 16, v64
    v_add_f32 v72, 0x3727c5ac, v72
    v_mov_b32 v67, v66
    v_cvt_pk_bf16_f32 v72, v72, v72
    v_lshlrev_b32 v72, 16, v72
    v_sqrt_f32 v72, v72
    v_pk_add_f32 v[48:49], v[32:33], v[66:67] neg_lo:[0,1] neg_hi:[0,1]
    v_pk_add_f32 v[50:51], v[34:35], v[66:67] neg_lo:[0,1] neg_hi:[0,1]
    v_pk_add_f32 v[52:53], v[36:37], v[66:67] neg_lo:[0,1] neg_hi:[0,1]
    v_pk_add_f32 v[54:55], v[38:39], v[66:67] neg_lo:[0,1] neg_hi:[0,1]
    v_pk_add_f32 v[56:57], v[40:41], v[66:67] neg_lo:[0,1] neg_hi:[0,1]
    v_pk_add_f32 v[58:59], v[42:43], v[66:67] neg_lo:[0,1] neg_hi:[0,1]
    v_pk_add_f32 v[60:61], v[44:45], v[66:67] neg_lo:[0,1] neg_hi:[0,1]
    v_pk_add_f32 v[62:63], v[46:47], v[66:67] neg_lo:[0,1] neg_hi:[0,1]
    v_cvt_pk_bf16_f32 v72, v72, v72
    v_lshlrev_b32 v72, 16, v72
    v_rcp_f32 v68, v72
    v_and_or_b32 v78, v64, s55, v72
    s_waitcnt lgkmcnt(0)
    s_add_u32 s10, s10, 0x9e3779b1
    s_andn2_b32 s10, s10, 15
    s_or_b32 s54, s10, s99
    v_mov_b32 v79, s54
    v_mov_b32 v70, s10
    s_mov_b32 exec_lo, 1
    s_mov_b32 exec_hi, 1
    global_store_dwordx2 v76, v[78:79], s[48:49] sc0 sc1
    s_mov_b64 exec, 1
    ds_write_b32 v29, v70
    ds_add_u32 v30, v31
    s_mov_b64 exec, -1
    s_setprio 1
    v_cvt_pk_bf16_f32 v8, v48, v49
    v_cvt_pk_bf16_f32 v9, v50, v51
    v_cvt_pk_bf16_f32 v10, v52, v53
    v_cvt_pk_bf16_f32 v11, v54, v55
    v_cvt_pk_bf16_f32 v12, v56, v57
    v_cvt_pk_bf16_f32 v13, v58, v59
    v_cvt_pk_bf16_f32 v14, v60, v61
    v_cvt_pk_bf16_f32 v15, v62, v63
    v_mov_b32 v69, v68
    v_lshlrev_b32 v48, 16, v8
    v_and_b32 v49, 0xffff0000, v8
    v_lshlrev_b32 v50, 16, v9
    v_and_b32 v51, 0xffff0000, v9
    v_lshlrev_b32 v52, 16, v10
    v_and_b32 v53, 0xffff0000, v10
    v_lshlrev_b32 v54, 16, v11
    v_and_b32 v55, 0xffff0000, v11
    v_lshlrev_b32 v56, 16, v12
    v_and_b32 v57, 0xffff0000, v12
    v_lshlrev_b32 v58, 16, v13
    v_and_b32 v59, 0xffff0000, v13
    v_lshlrev_b32 v60, 16, v14
    v_and_b32 v61, 0xffff0000, v14
    v_lshlrev_b32 v62, 16, v15
    v_and_b32 v63, 0xffff0000, v15
    v_pk_mul_f32 v[48:49], v[48:49], v[68:69]
    v_pk_mul_f32 v[50:51], v[50:51], v[68:69]
    v_pk_mul_f32 v[52:53], v[52:53], v[68:69]
    v_pk_mul_f32 v[54:55], v[54:55], v[68:69]
    v_pk_mul_f32 v[56:57], v[56:57], v[68:69]
    v_pk_mul_f32 v[58:59], v[58:59], v[68:69]
    v_pk_mul_f32 v[60:61], v[60:61], v[68:69]
    v_pk_mul_f32 v[62:63], v[62:63], v[68:69]
    v_cvt_pk_bf16_f32 v8, v48, v49
    v_cvt_pk_bf16_f32 v9, v50, v51
    v_cvt_pk_bf16_f32 v10, v52, v53
    v_cvt_pk_bf16_f32 v11, v54, v55
    v_cvt_pk_bf16_f32 v12, v56, v57
    v_cvt_pk_bf16_f32 v13, v58, v59
    v_cvt_pk_bf16_f32 v14, v60, v61
    v_cvt_pk_bf16_f32 v15, v62, v63
    s_waitcnt vmcnt(1)
    v_mov_b32 v70, 0
    v_mov_b32 v71, 0
    v_mov_b32 v72, 0
    v_mov_b32 v73, 0
    v_dot2c_f32_bf16 v70, v8, v16
    v_dot2c_f32_bf16 v71, v9, v17
    v_dot2c_f32_bf16 v72, v10, v18
    v_dot2c_f32_bf16 v73, v11, v19
    v_dot2c_f32_bf16 v70, v12, v20
    v_dot2c_f32_bf16 v71, v13, v21
    v_dot2c_f32_bf16 v72, v14, v22
    v_dot2c_f32_bf16 v73, v15, v23
    v_lshrrev_b32 v74, 3, v76
    v_sub_u32 v74, 0x7ff, v74
    v_lshrrev_b32 v75, 1, v76
    v_and_b32 v75, 28, v75
    v_add_u32 v75, 124416, v75
    v_add_f32 v70, v70, v71
    v_add_f32 v72, v72, v73
    v_add_f32 v70, v70, v72
    s_nop 1
    v_add_f32_dpp v70, v70, v70 quad_perm:[1,0,3,2] row_mask:0xf bank_mask:0xf
    s_nop 1
    v_add_f32_dpp v70, v70, v70 quad_perm:[2,3,0,1] row_mask:0xf bank_mask:0xf
    s_nop 1
    v_add_f32_dpp v70, v70, v70 row_half_mirror row_mask:0xf bank_mask:0xf
    s_nop 1
    v_add_f32_dpp v70, v70, v70 row_mirror row_mask:0xf bank_mask:0xf
    v_mov_b32 v71, v70
    s_nop 1
    v_permlane16_swap_b32 v70, v71
    v_add_f32 v70, v70, v71
    v_cvt_pk_bf16_f32 v70, v70, v70
    v_ashrrev_i32 v72, 31, v70
    v_or_b32 v72, 0x80008000, v72
    v_xor_b32 v70, v70, v72
    v_lshl_or_b32 v70, v70, 16, v74
    v_mov_b32 v30, 124532
    s_mov_b32 exec_lo, 1
    s_mov_b32 exec_hi, 1
    ds_write_b32 v75, v70
    s_mov_b64 exec, 1
    ds_add_u32 v30, v31
    s_mov_b64 exec, -1
    s_cmp_eq_u32 s3, 0
    s_cbranch_scc0 L_LDONE
    v_mov_b32 v30, 124532
    s_mov_b32 s62, 0
LW_LK:
    ds_read_b32 v29, v30
    s_add_u32 s62, s62, 1
    s_waitcnt lgkmcnt(0)
    v_readfirstlane_b32 s63, v29
    s_cmp_ge_u32 s63, 4
    s_cbranch_scc1 LWD_LK
    s_cmp_lt_u32 s62, 262144
    s_cbranch_scc1 LW_LK
LWD_LK:
    v_mov_b32 v30, 124416
    ds_read_b128 v[16:19], v30
    ds_read_b128 v[20:23], v30 offset:16
    s_lshl_b32 s12, s2, 4
    s_add_u32 s12, s12, 16384
    v_mov_b32 v30, s12
    v_mov_b32 v11, s10
    s_waitcnt lgkmcnt(0)
    v_max_u32 v12, v16, v17
    v_min_u32 v16, v16, v17
    v_max_u32 v13, v18, v19
    v_min_u32 v18, v18, v19
    v_max_u32 v14, v20, v21
    v_min_u32 v20, v20, v21
    v_max_u32 v15, v22, v23
    v_min_u32 v22, v22, v23
    v_min_u32 v17, v12, v13
    v_min_u32 v21, v14, v15
    v_max_u32 v12, v12, v13
    v_max_u32 v14, v14, v15
    v_max3_u32 v16, v16, v17, v18
    v_max3_u32 v20, v20, v21, v22
    v_min_u32 v17, v12, v14
    v_max_u32 v8, v12, v14
    v_max3_u32 v9, v16, v17, v20
    s_mov_b64 exec, 1
    global_store_dwordx4 v30, v[8:11], s[48:49] sc0 sc1
    s_mov_b64 exec, -1
L_LDONE:
    s_setprio 0
    s_branch L_COMMON
L_BTASK:
    global_load_dwordx2 v[140:141], v78, s[16:17]
    global_load_dwordx2 v[142:143], v78, s[16:17] offset:1024
    global_load_dwordx2 v[144:145], v78, s[16:17] offset:2048
    global_load_dwordx2 v[146:147], v78, s[16:17] offset:3072
    global_load_dwordx4 v[148:151], v134, s[48:49] sc1
    global_load_dwordx4 v[152:155], v135, s[48:49] sc1
    global_load_dword v137, v136, s[48:49] sc1
    s_waitcnt lgkmcnt(0)
    s_lshl_b32 s57, s7, 4
    s_lshr_b32 s56, s56, s57
    s_lshl_b32 s56, s56, 16
    v_mov_b32 v24, 0x3fb8aa3b
    v_mul_f32 v24, s56, v24
    v_exp_f32 v24, v24
    s_lshl_b32 s58, s13, 4
    s_sub_u32 s59, 16, s58
    s_lshl_b32 s60, s13, 8
    s_mul_i32 s61, s7, 34816
    s_add_u32 s60, s60, s61
    v_lshlrev_b32 v28, 2, v1
    v_add_u32 v28, s60, v28
    v_cvt_pk_bf16_f32 v24, v24, v24
    v_lshlrev_b32 v24, 16, v24
    s_waitcnt vmcnt(7)
    v_lshrrev_b32 v26, s58, v80
    v_lshrrev_b32 v27, s58, v81
    v_lshlrev_b32 v26, 16, v26
    v_lshlrev_b32 v27, 16, v27
    v_mul_f32 v26, v24, v26
    v_mul_f32 v27, v24, v27
    v_mul_f32 v26, 0x3fb8aa3b, v26
    v_mul_f32 v27, 0.15915494, v27
    v_mul_f32 v46, 0x41000000, v26
    v_mul_f32 v47, 0x41000000, v27
    v_exp_f32 v46, v46
    v_fract_f32 v47, v47
    v_cos_f32 v42, v47
    v_sin_f32 v43, v47
    v_mul_f32 v42, v46, v42
    v_mul_f32 v43, v46, v43
    v_mov_b32 v92, 0x3c00
    ds_write_b32 v28, v92 offset:17408
    v_pk_mul_f32 v[44:45], v[42:43], v[42:43] op_sel:[0,0] op_sel_hi:[0,1]
    v_pk_fma_f32 v[44:45], v[42:43], v[42:43], v[44:45] op_sel:[1,1,0] op_sel_hi:[1,0,1] neg_lo:[1,0,0]
    v_cvt_pk_f16_f32 v93, v42, v43
    ds_write_b32 v28, v93 offset:17952
    v_cvt_pk_f16_f32 v94, v44, v45
    ds_write_b32 v28, v94 offset:18496
    v_pk_mul_f32 v[50:51], v[44:45], v[44:45] op_sel:[0,0] op_sel_hi:[0,1]
    v_pk_fma_f32 v[50:51], v[44:45], v[44:45], v[50:51] op_sel:[1,1,0] op_sel_hi:[1,0,1] neg_lo:[1,0,0]
    v_pk_mul_f32 v[54:55], v[44:45], v[42:43] op_sel:[0,0] op_sel_hi:[0,1]
    v_pk_fma_f32 v[54:55], v[44:45], v[42:43], v[54:55] op_sel:[1,1,0] op_sel_hi:[1,0,1] neg_lo:[1,0,0]
    v_cvt_pk_f16_f32 v95, v50, v51
    ds_write_b32 v28, v95 offset:19584
    v_cvt_pk_f16_f32 v96, v54, v55
    ds_write_b32 v28, v96 offset:19040
    v_pk_mul_f32 v[48:49], v[50:51], v[44:45] op_sel:[0,0] op_sel_hi:[0,1]
    v_pk_fma_f32 v[48:49], v[50:51], v[44:45], v[48:49] op_sel:[1,1,0] op_sel_hi:[1,0,1] neg_lo:[1,0,0]
    v_pk_mul_f32 v[52:53], v[50:51], v[42:43] op_sel:[0,0] op_sel_hi:[0,1]
    v_pk_fma_f32 v[52:53], v[50:51], v[42:43], v[52:53] op_sel:[1,1,0] op_sel_hi:[1,0,1] neg_lo:[1,0,0]
    v_cvt_pk_f16_f32 v97, v48, v49
    ds_write_b32 v28, v97 offset:20672
    v_cvt_pk_f16_f32 v92, v52, v53
    ds_write_b32 v28, v92 offset:20128
    v_pk_mul_f32 v[50:51], v[48:49], v[44:45] op_sel:[0,0] op_sel_hi:[0,1]
    v_pk_fma_f32 v[50:51], v[48:49], v[44:45], v[50:51] op_sel:[1,1,0] op_sel_hi:[1,0,1] neg_lo:[1,0,0]
    v_pk_mul_f32 v[54:55], v[48:49], v[42:43] op_sel:[0,0] op_sel_hi:[0,1]
    v_pk_fma_f32 v[54:55], v[48:49], v[42:43], v[54:55] op_sel:[1,1,0] op_sel_hi:[1,0,1] neg_lo:[1,0,0]
    v_cvt_pk_f16_f32 v93, v50, v51
    ds_write_b32 v28, v93 offset:21760
    v_cvt_pk_f16_f32 v94, v54, v55
    ds_write_b32 v28, v94 offset:21216
    v_pk_mul_f32 v[48:49], v[50:51], v[44:45] op_sel:[0,0] op_sel_hi:[0,1]
    v_pk_fma_f32 v[48:49], v[50:51], v[44:45], v[48:49] op_sel:[1,1,0] op_sel_hi:[1,0,1] neg_lo:[1,0,0]
    v_pk_mul_f32 v[52:53], v[50:51], v[42:43] op_sel:[0,0] op_sel_hi:[0,1]
    v_pk_fma_f32 v[52:53], v[50:51], v[42:43], v[52:53] op_sel:[1,1,0] op_sel_hi:[1,0,1] neg_lo:[1,0,0]
    v_cvt_pk_f16_f32 v95, v48, v49
    ds_write_b32 v28, v95 offset:22848
    v_cvt_pk_f16_f32 v96, v52, v53
    ds_write_b32 v28, v96 offset:22304
    v_pk_mul_f32 v[50:51], v[48:49], v[44:45] op_sel:[0,0] op_sel_hi:[0,1]
    v_pk_fma_f32 v[50:51], v[48:49], v[44:45], v[50:51] op_sel:[1,1,0] op_sel_hi:[1,0,1] neg_lo:[1,0,0]
    v_pk_mul_f32 v[54:55], v[48:49], v[42:43] op_sel:[0,0] op_sel_hi:[0,1]
    v_pk_fma_f32 v[54:55], v[48:49], v[42:43], v[54:55] op_sel:[1,1,0] op_sel_hi:[1,0,1] neg_lo:[1,0,0]
    v_cvt_pk_f16_f32 v97, v50, v51
    ds_write_b32 v28, v97 offset:23936
    v_cvt_pk_f16_f32 v92, v54, v55
    ds_write_b32 v28, v92 offset:23392
    v_pk_mul_f32 v[48:49], v[50:51], v[44:45] op_sel:[0,0] op_sel_hi:[0,1]
    v_pk_fma_f32 v[48:49], v[50:51], v[44:45], v[48:49] op_sel:[1,1,0] op_sel_hi:[1,0,1] neg_lo:[1,0,0]
    v_pk_mul_f32 v[52:53], v[50:51], v[42:43] op_sel:[0,0] op_sel_hi:[0,1]
    v_pk_fma_f32 v[52:53], v[50:51], v[42:43], v[52:53] op_sel:[1,1,0] op_sel_hi:[1,0,1] neg_lo:[1,0,0]
    v_cvt_pk_f16_f32 v93, v48, v49
    ds_write_b32 v28, v93 offset:25024
    v_cvt_pk_f16_f32 v94, v52, v53
    ds_write_b32 v28, v94 offset:24480
    v_pk_mul_f32 v[50:51], v[48:49], v[44:45] op_sel:[0,0] op_sel_hi:[0,1]
    v_pk_fma_f32 v[50:51], v[48:49], v[44:45], v[50:51] op_sel:[1,1,0] op_sel_hi:[1,0,1] neg_lo:[1,0,0]
    v_pk_mul_f32 v[54:55], v[48:49], v[42:43] op_sel:[0,0] op_sel_hi:[0,1]
    v_pk_fma_f32 v[54:55], v[48:49], v[42:43], v[54:55] op_sel:[1,1,0] op_sel_hi:[1,0,1] neg_lo:[1,0,0]
    v_cvt_pk_f16_f32 v95, v50, v51
    ds_write_b32 v28, v95 offset:26112
    v_cvt_pk_f16_f32 v96, v54, v55
    ds_write_b32 v28, v96 offset:25568
    v_pk_mul_f32 v[48:49], v[50:51], v[44:45] op_sel:[0,0] op_sel_hi:[0,1]
    v_pk_fma_f32 v[48:49], v[50:51], v[44:45], v[48:49] op_sel:[1,1,0] op_sel_hi:[1,0,1] neg_lo:[1,0,0]
    v_pk_mul_f32 v[52:53], v[50:51], v[42:43] op_sel:[0,0] op_sel_hi:[0,1]
    v_pk_fma_f32 v[52:53], v[50:51], v[42:43], v[52:53] op_sel:[1,1,0] op_sel_hi:[1,0,1] neg_lo:[1,0,0]
    v_cvt_pk_f16_f32 v97, v48, v49
    ds_write_b32 v28, v97 offset:27200
    v_cvt_pk_f16_f32 v92, v52, v53
    ds_write_b32 v28, v92 offset:26656
    v_pk_mul_f32 v[50:51], v[48:49], v[44:45] op_sel:[0,0] op_sel_hi:[0,1]
    v_pk_fma_f32 v[50:51], v[48:49], v[44:45], v[50:51] op_sel:[1,1,0] op_sel_hi:[1,0,1] neg_lo:[1,0,0]
    v_pk_mul_f32 v[54:55], v[48:49], v[42:43] op_sel:[0,0] op_sel_hi:[0,1]
    v_pk_fma_f32 v[54:55], v[48:49], v[42:43], v[54:55] op_sel:[1,1,0] op_sel_hi:[1,0,1] neg_lo:[1,0,0]
    v_cvt_pk_f16_f32 v93, v50, v51
    ds_write_b32 v28, v93 offset:28288
    v_cvt_pk_f16_f32 v94, v54, v55
    ds_write_b32 v28, v94 offset:27744
    v_pk_mul_f32 v[48:49], v[50:51], v[44:45] op_sel:[0,0] op_sel_hi:[0,1]
    v_pk_fma_f32 v[48:49], v[50:51], v[44:45], v[48:49] op_sel:[1,1,0] op_sel_hi:[1,0,1] neg_lo:[1,0,0]
    v_pk_mul_f32 v[52:53], v[50:51], v[42:43] op_sel:[0,0] op_sel_hi:[0,1]
    v_pk_fma_f32 v[52:53], v[50:51], v[42:43], v[52:53] op_sel:[1,1,0] op_sel_hi:[1,0,1] neg_lo:[1,0,0]
    v_cvt_pk_f16_f32 v95, v48, v49
    ds_write_b32 v28, v95 offset:29376
    v_cvt_pk_f16_f32 v96, v52, v53
    ds_write_b32 v28, v96 offset:28832
    v_pk_mul_f32 v[50:51], v[48:49], v[44:45] op_sel:[0,0] op_sel_hi:[0,1]
    v_pk_fma_f32 v[50:51], v[48:49], v[44:45], v[50:51] op_sel:[1,1,0] op_sel_hi:[1,0,1] neg_lo:[1,0,0]
    v_pk_mul_f32 v[54:55], v[48:49], v[42:43] op_sel:[0,0] op_sel_hi:[0,1]
    v_pk_fma_f32 v[54:55], v[48:49], v[42:43], v[54:55] op_sel:[1,1,0] op_sel_hi:[1,0,1] neg_lo:[1,0,0]
    v_cvt_pk_f16_f32 v97, v50, v51
    ds_write_b32 v28, v97 offset:30464
    v_cvt_pk_f16_f32 v92, v54, v55
    ds_write_b32 v28, v92 offset:29920
    v_pk_mul_f32 v[48:49], v[50:51], v[44:45] op_sel:[0,0] op_sel_hi:[0,1]
    v_pk_fma_f32 v[48:49], v[50:51], v[44:45], v[48:49] op_sel:[1,1,0] op_sel_hi:[1,0,1] neg_lo:[1,0,0]
    v_pk_mul_f32 v[52:53], v[50:51], v[42:43] op_sel:[0,0] op_sel_hi:[0,1]
    v_pk_fma_f32 v[52:53], v[50:51], v[42:43], v[52:53] op_sel:[1,1,0] op_sel_hi:[1,0,1] neg_lo:[1,0,0]
    v_cvt_pk_f16_f32 v93, v48, v49
    ds_write_b32 v28, v93 offset:31552
    v_cvt_pk_f16_f32 v94, v52, v53
    ds_write_b32 v28, v94 offset:31008
    v_pk_mul_f32 v[50:51], v[48:49], v[44:45] op_sel:[0,0] op_sel_hi:[0,1]
    v_pk_fma_f32 v[50:51], v[48:49], v[44:45], v[50:51] op_sel:[1,1,0] op_sel_hi:[1,0,1] neg_lo:[1,0,0]
    v_pk_mul_f32 v[54:55], v[48:49], v[42:43] op_sel:[0,0] op_sel_hi:[0,1]
    v_pk_fma_f32 v[54:55], v[48:49], v[42:43], v[54:55] op_sel:[1,1,0] op_sel_hi:[1,0,1] neg_lo:[1,0,0]
    v_cvt_pk_f16_f32 v95, v50, v51
    ds_write_b32 v28, v95 offset:32640
    v_cvt_pk_f16_f32 v96, v54, v55
    ds_write_b32 v28, v96 offset:32096
    v_pk_mul_f32 v[48:49], v[50:51], v[44:45] op_sel:[0,0] op_sel_hi:[0,1]
    v_pk_fma_f32 v[48:49], v[50:51], v[44:45], v[48:49] op_sel:[1,1,0] op_sel_hi:[1,0,1] neg_lo:[1,0,0]
    v_pk_mul_f32 v[52:53], v[50:51], v[42:43] op_sel:[0,0] op_sel_hi:[0,1]
    v_pk_fma_f32 v[52:53], v[50:51], v[42:43], v[52:53] op_sel:[1,1,0] op_sel_hi:[1,0,1] neg_lo:[1,0,0]
    v_cvt_pk_f16_f32 v97, v48, v49
    ds_write_b32 v28, v97 offset:33728
    v_cvt_pk_f16_f32 v92, v52, v53
    ds_write_b32 v28, v92 offset:33184
    v_pk_mul_f32 v[54:55], v[48:49], v[42:43] op_sel:[0,0] op_sel_hi:[0,1]
    v_pk_fma_f32 v[54:55], v[48:49], v[42:43], v[54:55] op_sel:[1,1,0] op_sel_hi:[1,0,1] neg_lo:[1,0,0]
    v_cvt_pk_f16_f32 v93, v54, v55
    ds_write_b32 v28, v93 offset:34272
    s_setprio 2
    s_waitcnt vmcnt(0)
    ds_bpermute_b32 v148, v133, v140
    ds_bpermute_b32 v149, v133, v142
    ds_bpermute_b32 v150, v133, v144
    ds_bpermute_b32 v151, v133, v146
    ds_bpermute_b32 v152, v133, v141
    ds_bpermute_b32 v153, v133, v143
    ds_bpermute_b32 v154, v133, v145
    ds_bpermute_b32 v155, v133, v147
    s_waitcnt lgkmcnt(4)
    global_store_dwordx4 v134, v[148:151], s[48:49]
    s_waitcnt lgkmcnt(0)
    global_store_dwordx4 v135, v[152:155], s[48:49]
    v_alignbit_b32 v14, v149, v149, 25
    v_alignbit_b32 v15, v150, v150, 19
    v_alignbit_b32 v12, v151, v151, 10
    v_add3_u32 v14, v14, v15, v148
    v_add_u32 v12, v12, v14
    v_mul_lo_u32 v12, v12, v127
    v_alignbit_b32 v14, v153, v153, 25
    v_alignbit_b32 v15, v154, v154, 19
    v_alignbit_b32 v13, v155, v155, 10
    v_add3_u32 v14, v14, v15, v152
    v_add_u32 v13, v13, v14
    v_mul_lo_u32 v13, v13, v127
    v_add_u32_dpp v12, v12, v12 quad_perm:[1,0,3,2] row_mask:0xf bank_mask:0xf
    s_nop 0
    v_add_u32_dpp v13, v13, v13 quad_perm:[1,0,3,2] row_mask:0xf bank_mask:0xf
    v_add_u32_dpp v12, v12, v12 quad_perm:[2,3,0,1] row_mask:0xf bank_mask:0xf
    s_nop 0
    v_add_u32_dpp v13, v13, v13 quad_perm:[2,3,0,1] row_mask:0xf bank_mask:0xf
    v_add_u32_dpp v12, v12, v12 row_half_mirror row_mask:0xf bank_mask:0xf
    s_nop 0
    v_add_u32_dpp v13, v13, v13 row_half_mirror row_mask:0xf bank_mask:0xf
    v_add_u32_dpp v12, v12, v12 row_mirror row_mask:0xf bank_mask:0xf
    s_nop 0
    v_add_u32_dpp v13, v13, v13 row_mirror row_mask:0xf bank_mask:0xf
    v_mov_b32 v14, 124516
    s_mov_b32 s62, 0
LW_N:
    ds_read_b32 v15, v14
    s_add_u32 s62, s62, 1
    s_waitcnt lgkmcnt(0)
    v_readfirstlane_b32 s63, v15
    s_cmp_ge_u32 s63, 1
    s_cbranch_scc1 LWD_N
    s_cmp_lt_u32 s62, 262144
    s_cbranch_scc1 LW_N
LWD_N:
    v_mov_b32 v14, 124480
    ds_read_b32 v14, v14
    s_waitcnt lgkmcnt(0)
    v_add_u32 v12, v14, v12
    v_add_u32 v13, v14, v13
    s_mov_b32 exec_lo, 0x00010001
    s_mov_b32 exec_hi, 0x00010001
    global_store_dwordx2 v136, v[12:13], s[48:49]
    s_mov_b64 exec, -1
    s_setprio 0
L_COMMON:
    s_waitcnt lgkmcnt(0)
    s_barrier
    ds_read_b128 v[32:35], v108 offset:0
    ds_read_b128 v[36:39], v109 offset:0
    ds_read_b128 v[40:43], v108 offset:64
    ds_read_b128 v[44:47], v109 offset:64
    ds_read_b128 v[48:51], v108 offset:128
    ds_read_b128 v[52:55], v109 offset:128
    ds_read_b128 v[56:59], v108 offset:192
    ds_read_b128 v[60:63], v109 offset:192
    ds_read_b128 v[64:67], v108 offset:256
    ds_read_b128 v[68:71], v109 offset:256
    ds_read_b128 v[72:75], v108 offset:320
    ds_read_b128 v[76:79], v109 offset:320
    ds_read_b128 v[80:83], v108 offset:384
    ds_read_b128 v[84:87], v109 offset:384
    ds_read_b128 v[88:91], v108 offset:448
    ds_read_b128 v[92:95], v109 offset:448
    s_waitcnt lgkmcnt(14)
    v_mfma_f32_16x16x32_f16 v[96:99], v[32:35], v[36:39], 0
    s_waitcnt lgkmcnt(12)
    v_mfma_f32_16x16x32_f16 v[96:99], v[40:43], v[44:47], v[96:99]
    s_waitcnt lgkmcnt(10)
    v_mfma_f32_16x16x32_f16 v[96:99], v[48:51], v[52:55], v[96:99]
    s_waitcnt lgkmcnt(8)
    v_mfma_f32_16x16x32_f16 v[96:99], v[56:59], v[60:63], v[96:99]
    s_waitcnt lgkmcnt(6)
    v_mfma_f32_16x16x32_f16 v[96:99], v[64:67], v[68:71], v[96:99]
    s_waitcnt lgkmcnt(4)
    v_mfma_f32_16x16x32_f16 v[96:99], v[72:75], v[76:79], v[96:99]
    s_waitcnt lgkmcnt(2)
    v_mfma_f32_16x16x32_f16 v[96:99], v[80:83], v[84:87], v[96:99]
    s_waitcnt lgkmcnt(0)
    v_mfma_f32_16x16x32_f16 v[96:99], v[88:91], v[92:95], v[96:99]
    v_mov_b32 v40, 124480
    ds_read_b32 v40, v40
    s_nop 5
    v_cvt_pk_f16_f32 v32, v96, v97
    v_cvt_pk_f16_f32 v33, v98, v99
    s_cmp_eq_u32 s7, 0
    s_cbranch_scc0 L_KX1
    v_perm_b32 v34, v33, v32, v100
    v_perm_b32 v35, v33, v32, v101
    ds_write_b64 v110, v[34:35]
    s_branch L_KXD
L_KX1:
    v_perm_b32 v36, v33, v32, v100
    v_perm_b32 v37, v33, v32, v101
    v_perm_b32 v38, v33, v32, v102
    v_perm_b32 v39, v33, v32, v103
    ds_write_b128 v110, v[36:39]
    v_perm_b32 v44, v33, v33, v100
    v_perm_b32 v45, v33, v33, v101
    v_perm_b32 v46, v33, v33, v102
    v_perm_b32 v47, v33, v33, v103
    s_mov_b32 exec_lo, 0
    ds_write_b128 v111, v[44:47]
    s_mov_b32 exec_lo, -1
L_KXD:
    s_waitcnt vmcnt(0)
    global_load_dword v125, v124, s[48:49] sc1
    global_load_dwordx4 v[160:163], v126, s[48:49] sc1
    global_load_dwordx4 v[116:119], v115, s[48:49] sc0 sc1
    global_load_dwordx4 v[120:123], v115, s[48:49] offset:16 sc0 sc1
    s_waitcnt lgkmcnt(0)
    v_readfirstlane_b32 s10, v40
    s_mov_b32 s62, 0
    s_cmp_eq_u32 s3, 5
    s_cbranch_scc0 L_NOPAD
    v_mov_b32 v32, 0
    v_mov_b32 v33, 0
    v_mov_b32 v34, 0
    v_mov_b32 v35, 0
    v_bfe_u32 v36, v1, 1, 3
    v_mul_u32_u24 v36, 4160, v36
    v_and_b32 v37, 1, v1
    v_lshl_add_u32 v36, v37, 4, v36
    v_add_u32 v36, 78848, v36
    s_mov_b64 exec, 0xffff
    ds_write_b128 v36, v[32:35]
    s_mov_b64 exec, -1
L_NOPAD:
    s_mov_b64 s[56:57], 0
    v_lshrrev_b32 v37, 6, v4
    v_lshlrev_b32 v37, 9, v37
    s_lshl_b32 s50, s5, 6
    v_add_u32 v37, s50, v37
    s_or_b32 s54, s10, s99
L_GPOLL:
    s_waitcnt vmcnt(0)
    v_alignbit_b32 v33, v161, v161, 25
    v_alignbit_b32 v34, v162, v162, 19
    v_alignbit_b32 v32, v163, v163, 10
    v_add3_u32 v33, v33, v34, v160
    v_add_u32 v32, v32, v33
    v_mul_lo_u32 v32, v32, v127
    s_nop 1
    v_add_u32_dpp v32, v32, v32 quad_perm:[1,0,3,2] row_mask:0xf bank_mask:0xf
    s_nop 1
    v_add_u32_dpp v32, v32, v32 quad_perm:[2,3,0,1] row_mask:0xf bank_mask:0xf
    s_nop 1
    v_add_u32_dpp v32, v32, v32 row_half_mirror row_mask:0xf bank_mask:0xf
    s_nop 1
    v_add_u32_dpp v32, v32, v32 row_mirror row_mask:0xf bank_mask:0xf
    v_add_u32 v32, s10, v32
    v_cmp_ne_u32 vcc, v32, v125
    v_xor_b32 v33, s10, v117
    v_xor_b32 v34, s10, v119
    v_xor_b32 v35, s10, v121
    v_xor_b32 v36, s10, v123
    v_or3_b32 v34, v33, v34, v35
    v_or_b32 v34, v34, v36
    v_cmp_lt_u32 s[50:51], 15, v34
    s_andn2_b64 vcc, vcc, s[56:57]
    s_or_b64 s[52:53], vcc, s[50:51]
    s_cbranch_scc0 L_GOK
    s_add_u32 s62, s62, 1
    s_cmp_ge_u32 s62, 262144
    s_cbranch_scc1 L_GOK
    s_mov_b64 exec, vcc
    s_cbranch_execz L_GP2
    s_cmp_lt_u32 s62, 4
    s_cbranch_scc1 L_GP1
    global_load_dword v38, v37, s[48:49] offset:4 sc0 sc1
    s_waitcnt vmcnt(0)
    v_xor_b32 v38, s54, v38
    v_cmp_ne_u32 s[52:53], 0, v38
    v_cmp_gt_u32 s[58:59], 16, v38
    s_and_b64 s[52:53], s[52:53], s[58:59]
    s_or_b64 s[56:57], s[56:57], s[52:53]
    s_mov_b64 exec, s[52:53]
    s_cbranch_execz L_GP0
    global_load_dword v160, v3, s[16:17]
    global_load_dword v161, v3, s[16:17] offset:1024
    global_load_dword v162, v3, s[16:17] offset:2048
    global_load_dword v163, v3, s[16:17] offset:3072
L_GP0:
    s_andn2_b64 exec, vcc, s[52:53]
    s_cbranch_execz L_GP2
L_GP1:
    global_load_dword v125, v124, s[48:49] sc1
    global_load_dwordx4 v[160:163], v126, s[48:49] sc1
L_GP2:
    s_mov_b64 exec, s[50:51]
    s_cbranch_execz L_GP3
    s_sleep 3
    global_load_dwordx4 v[116:119], v115, s[48:49] sc0 sc1
    global_load_dwordx4 v[120:123], v115, s[48:49] offset:16 sc0 sc1
L_GP3:
    s_mov_b64 exec, -1
    s_branch L_GPOLL
L_GOK:
    v_mov_b32 v34, 124528
    v_mov_b32 v35, 1
    s_mov_b64 exec, 1
    ds_add_u32 v34, v35
    s_mov_b64 exec, -1
    v_bfe_u32 v35, v4, 3, 3
    v_and_b32 v36, 15, v119
    v_cmp_eq_u32 vcc, s5, v35
    v_cmp_ne_u32 s[50:51], s99, v36
    s_and_b64 vcc, vcc, s[50:51]
    s_cbranch_vccz L_UNI
    v_mov_b32 v34, 124544
    v_mov_b32 v35, 1
    s_mov_b64 exec, 1
    ds_add_u32 v34, v35
    s_mov_b64 exec, -1
L_UNI:
    v_and_b32 v40, 0xffff0000, v116
    v_and_b32 v41, 0xffff0000, v118
    v_and_b32 v42, 0xffff0000, v120
    v_and_b32 v43, 0xffff0000, v122
    v_rcp_f32 v40, v40
    v_rcp_f32 v41, v41
    v_rcp_f32 v42, v42
    v_rcp_f32 v43, v43
    v_lshlrev_b32 v44, 16, v116
    v_lshlrev_b32 v45, 16, v118
    v_lshlrev_b32 v46, 16, v120
    v_lshlrev_b32 v47, 16, v122
    v_lshlrev_b32 v48, 16, v160
    v_and_b32 v49, 0xffff0000, v160
    v_lshlrev_b32 v50, 16, v161
    v_and_b32 v51, 0xffff0000, v161
    v_lshlrev_b32 v52, 16, v162
    v_and_b32 v53, 0xffff0000, v162
    v_lshlrev_b32 v54, 16, v163
    v_and_b32 v55, 0xffff0000, v163
    v_sub_f32 v48, v48, v44
    v_sub_f32 v49, v49, v44
    v_sub_f32 v50, v50, v45
    v_sub_f32 v51, v51, v45
    v_sub_f32 v52, v52, v46
    v_sub_f32 v53, v53, v46
    v_sub_f32 v54, v54, v47
    v_sub_f32 v55, v55, v47
    v_mul_f32 v40, 0x45000000, v40
    v_mul_f32 v41, 0x45000000, v41
    v_mul_f32 v42, 0x45000000, v42
    v_mul_f32 v43, 0x45000000, v43
    v_cvt_pk_bf16_f32 v56, v48, v49
    v_cvt_pk_bf16_f32 v57, v50, v51
    v_cvt_pk_bf16_f32 v58, v52, v53
    v_cvt_pk_bf16_f32 v59, v54, v55
    v_lshlrev_b32 v48, 16, v56
    v_and_b32 v49, 0xffff0000, v56
    v_lshlrev_b32 v50, 16, v57
    v_and_b32 v51, 0xffff0000, v57
    v_lshlrev_b32 v52, 16, v58
    v_and_b32 v53, 0xffff0000, v58
    v_lshlrev_b32 v54, 16, v59
    v_and_b32 v55, 0xffff0000, v59
    v_mul_f32 v48, v48, v40
    v_mul_f32 v49, v49, v40
    v_mul_f32 v50, v50, v41
    v_mul_f32 v51, v51, v41
    v_mul_f32 v52, v52, v42
    v_mul_f32 v53, v53, v42
    v_mul_f32 v54, v54, v43
    v_mul_f32 v55, v55, v43
    v_cvt_pk_bf16_f32 v164, v48, v49
    v_cvt_pk_bf16_f32 v165, v50, v51
    v_cvt_pk_bf16_f32 v166, v52, v53
    v_cvt_pk_bf16_f32 v167, v54, v55
    v_lshlrev_b32 v48, 16, v164
    v_and_b32 v49, 0xffff0000, v164
    v_lshlrev_b32 v50, 16, v165
    v_and_b32 v51, 0xffff0000, v165
    v_lshlrev_b32 v52, 16, v166
    v_and_b32 v53, 0xffff0000, v166
    v_lshlrev_b32 v54, 16, v167
    v_and_b32 v55, 0xffff0000, v167
    v_cvt_pk_f16_f32 v60, v48, v50
    v_cvt_pk_f16_f32 v61, v52, v54
    v_cvt_pk_f16_f32 v62, v49, v51
    v_cvt_pk_f16_f32 v63, v53, v55
    ds_write_b64 v128, v[60:61]
    ds_write_b64 v128, v[62:63] offset:16640
    v_subrev_u32 v9, 8, v128
    s_waitcnt lgkmcnt(0)
    s_barrier
    ds_read_b64 v[64:65], v9
    ds_read_b64 v[66:67], v9 offset:16640
    v_alignbyte_b32 v69, v61, v60, 2
    v_mov_b32 v71, v60
    v_alignbyte_b32 v77, v63, v62, 2
    v_mov_b32 v79, v62
    s_waitcnt lgkmcnt(1)
    v_alignbyte_b32 v68, v60, v65, 2
    v_mov_b32 v70, v65
    v_alignbyte_b32 v72, v65, v64, 2
    v_alignbyte_b32 v73, v60, v65, 2
    ds_write_b64 v128, v[68:69] offset:4160
    ds_write_b64 v128, v[70:71] offset:8320
    ds_write_b64 v128, v[72:73] offset:12480
    s_waitcnt lgkmcnt(3)
    v_alignbyte_b32 v76, v62, v67, 2
    v_mov_b32 v78, v67
    v_alignbyte_b32 v80, v67, v66, 2
    v_alignbyte_b32 v81, v62, v67, 2
    ds_write_b64 v128, v[76:77] offset:20800
    ds_write_b64 v128, v[78:79] offset:24960
    ds_write_b64 v128, v[80:81] offset:29120
    s_lshl_b32 s50, s15, 16
    s_and_b32 s51, s15, 0xffff0000
    v_mov_b32 v156, 0x3a000000
    v_mul_f32 v157, s51, v156
    v_mul_f32 v156, s50, v156
    s_cmp_ge_u32 s3, 4
    s_cbranch_scc1 L_AUX
    s_setprio 2
    v_and_b32 v8, 15, v1
    v_lshrrev_b32 v9, 4, v1
    v_sub_u32 v10, 15, v8
    v_and_b32 v11, 3, v10
    v_lshrrev_b32 v10, 2, v10
    v_mul_u32_u24 v12, 4160, v11
    v_lshlrev_b32 v11, 1, v9
    v_sub_u32 v11, v11, v10
    v_add_u32 v11, 4, v11
    v_lshl_add_u32 v12, v11, 3, v12
    s_mul_i32 s12, s7, 16640
    s_lshl_b32 s14, s13, 8
    s_add_u32 s12, s12, s14
    s_add_u32 s12, s12, 78848
    v_add_u32 v12, s12, v12
    v_lshlrev_b32 v13, 4, v9
    v_lshlrev_b32 v11, 5, v8
    v_sub_u32 v13, v13, v11
    s_mul_i32 s12, s7, 4608
    s_add_u32 s12, s12, s14
    s_add_u32 s12, s12, 70112
    v_add_u32 v13, s12, v13
    v_lshl_add_u32 v14, v8, 2, v9
    v_bfe_u32 v11, v14, 3, 2
    v_xor_b32 v14, v14, v11
    s_lshl_b32 s12, s3, 10
    s_add_u32 s12, s12, 0
    v_lshl_add_u32 v14, v14, 4, s12
    v_mov_b32 v10, 124560
    v_mov_b32 v11, 1
    s_waitcnt lgkmcnt(0)
    s_barrier
    ds_read_b64 v[16:17], v12 offset:3584
    ds_read_b64 v[18:19], v12 offset:3592
    ds_read_b128 v[20:23], v13 offset:3584
    ds_read_b64 v[24:25], v12 offset:0
    ds_read_b64 v[26:27], v12 offset:8
    ds_read_b128 v[28:31], v13 offset:0
    ds_read_b64 v[32:33], v12 offset:3072
    ds_read_b64 v[34:35], v12 offset:3080
    ds_read_b128 v[36:39], v13 offset:512
    ds_read_b128 v[40:43], v13 offset:3072
    ds_read_b64 v[44:45], v12 offset:512
    ds_read_b64 v[46:47], v12 offset:520
    ds_read_b64 v[48:49], v12 offset:2560
    ds_read_b64 v[50:51], v12 offset:2568
    s_waitcnt lgkmcnt(11)
    v_mfma_f32_16x16x32_f16 v[124:127], v[16:19], v[20:23], 0
    ds_read_b128 v[52:55], v13 offset:1024
    s_waitcnt lgkmcnt(9)
    v_mfma_f32_16x16x32_f16 v[124:127], v[24:27], v[28:31], v[124:127]
    ds_read_b128 v[56:59], v13 offset:2560
    s_waitcnt lgkmcnt(8)
    v_mfma_f32_16x16x32_f16 v[120:123], v[32:35], v[20:23], 0
    ds_read_b64 v[60:61], v12 offset:1024
    ds_read_b64 v[62:63], v12 offset:1032
    s_waitcnt lgkmcnt(9)
    v_mfma_f32_16x16x32_f16 v[120:123], v[24:27], v[36:39], v[120:123]
    ds_read_b64 v[64:65], v12 offset:2048
    ds_read_b64 v[66:67], v12 offset:2056
    s_waitcnt lgkmcnt(10)
    v_mfma_f32_16x16x32_f16 v[124:127], v[32:35], v[40:43], v[124:127]
    ds_read_b128 v[68:71], v13 offset:1536
    s_waitcnt lgkmcnt(9)
    v_mfma_f32_16x16x32_f16 v[124:127], v[44:47], v[36:39], v[124:127]
    ds_read_b128 v[72:75], v13 offset:2048
    s_waitcnt lgkmcnt(8)
    v_mfma_f32_16x16x32_f16 v[116:119], v[48:51], v[20:23], 0
    ds_read_b64 v[76:77], v12 offset:1536
    ds_read_b64 v[78:79], v12 offset:1544
    s_waitcnt lgkmcnt(9)
    v_mfma_f32_16x16x32_f16 v[116:119], v[24:27], v[52:55], v[116:119]
    ds_read_b64 v[80:81], v12 offset:3648
    ds_read_b64 v[82:83], v12 offset:3656
    v_mfma_f32_16x16x32_f16 v[120:123], v[48:51], v[40:43], v[120:123]
    ds_read_b128 v[84:87], v13 offset:3648
    v_mfma_f32_16x16x32_f16 v[120:123], v[44:47], v[52:55], v[120:123]
    ds_read_b64 v[88:89], v12 offset:64
    ds_read_b64 v[90:91], v12 offset:72
    s_waitcnt lgkmcnt(13)
    v_mfma_f32_16x16x32_f16 v[124:127], v[48:51], v[56:59], v[124:127]
    v_lshlrev_b32 v148, 16, v164
    s_waitcnt lgkmcnt(11)
    v_mfma_f32_16x16x32_f16 v[124:127], v[60:63], v[52:55], v[124:127]
    ds_read_b128 v[92:95], v13 offset:64
    s_waitcnt lgkmcnt(10)
    v_mfma_f32_16x16x32_f16 v[112:115], v[64:67], v[20:23], 0
    ds_read_b64 v[16:17], v12 offset:3136
    ds_read_b64 v[18:19], v12 offset:3144
    s_waitcnt lgkmcnt(11)
    v_mfma_f32_16x16x32_f16 v[112:115], v[24:27], v[68:71], v[112:115]
    ds_read_b128 v[28:31], v13 offset:576
    v_mfma_f32_16x16x32_f16 v[116:119], v[64:67], v[40:43], v[116:119]
    ds_read_b128 v[32:35], v13 offset:3136
    v_mfma_f32_16x16x32_f16 v[116:119], v[44:47], v[68:71], v[116:119]
    v_and_b32 v149, 0xffff0000, v164
    v_mfma_f32_16x16x32_f16 v[120:123], v[64:67], v[56:59], v[120:123]
    v_lshlrev_b32 v150, 16, v165
    v_mfma_f32_16x16x32_f16 v[120:123], v[60:63], v[68:71], v[120:123]
    v_and_b32 v151, 0xffff0000, v165
    s_waitcnt lgkmcnt(12)
    v_mfma_f32_16x16x32_f16 v[124:127], v[64:67], v[72:75], v[124:127]
    ds_read_b64 v[36:37], v12 offset:576
    ds_read_b64 v[38:39], v12 offset:584
    s_waitcnt lgkmcnt(12)
    v_mfma_f32_16x16x32_f16 v[124:127], v[76:79], v[68:71], v[124:127]
    ds_read_b64 v[48:49], v12 offset:2624
    ds_read_b64 v[50:51], v12 offset:2632
    v_mfma_f32_16x16x32_f16 v[108:111], v[76:79], v[20:23], 0
    v_lshlrev_b32 v152, 16, v166
    v_mfma_f32_16x16x32_f16 v[108:111], v[24:27], v[72:75], v[108:111]
    v_and_b32 v153, 0xffff0000, v166
    v_mfma_f32_16x16x32_f16 v[112:115], v[76:79], v[40:43], v[112:115]
    v_lshlrev_b32 v154, 16, v167
    v_mfma_f32_16x16x32_f16 v[112:115], v[44:47], v[72:75], v[112:115]
    v_and_b32 v155, 0xffff0000, v167
    v_mfma_f32_16x16x32_f16 v[116:119], v[76:79], v[56:59], v[116:119]
    v_mul_f32 v140, v148, v156
    v_mfma_f32_16x16x32_f16 v[116:119], v[60:63], v[72:75], v[116:119]
    v_mul_f32 v141, v149, v157
    v_mfma_f32_16x16x32_f16 v[120:123], v[76:79], v[72:75], v[120:123]
    v_mul_f32 v142, v150, v156
    v_mfma_f32_16x16x32_f16 v[104:107], v[60:63], v[20:23], 0
    v_mul_f32 v143, v151, v157
    v_mfma_f32_16x16x32_f16 v[104:107], v[24:27], v[56:59], v[104:107]
    v_mul_f32 v144, v152, v156
    v_mfma_f32_16x16x32_f16 v[108:111], v[60:63], v[40:43], v[108:111]
    v_mul_f32 v145, v153, v157
    v_mfma_f32_16x16x32_f16 v[108:111], v[44:47], v[56:59], v[108:111]
    v_mul_f32 v146, v154, v156
    v_mfma_f32_16x16x32_f16 v[112:115], v[60:63], v[56:59], v[112:115]
    v_mul_f32 v147, v155, v157
    v_mfma_f32_16x16x32_f16 v[100:103], v[44:47], v[20:23], 0
    v_cvt_pk_bf16_f32 v140, v140, v141
    v_mfma_f32_16x16x32_f16 v[100:103], v[24:27], v[40:43], v[100:103]
    v_cvt_pk_bf16_f32 v142, v142, v143
    v_mfma_f32_16x16x32_f16 v[104:107], v[44:47], v[40:43], v[104:107]
    v_cvt_pk_bf16_f32 v144, v144, v145
    v_mfma_f32_16x16x32_f16 v[96:99], v[24:27], v[20:23], 0
    v_cvt_pk_bf16_f32 v146, v146, v147
    s_waitcnt lgkmcnt(11)
    v_mfma_f32_16x16x32_f16 v[124:127], v[80:83], v[84:87], v[124:127]
    ds_read_b128 v[52:55], v13 offset:1088
    s_waitcnt lgkmcnt(9)
    v_mfma_f32_16x16x32_f16 v[124:127], v[88:91], v[92:95], v[124:127]
    ds_read_b128 v[64:67], v13 offset:2624
    s_waitcnt lgkmcnt(8)
    v_mfma_f32_16x16x32_f16 v[120:123], v[16:19], v[84:87], v[120:123]
    ds_read_b64 v[68:69], v12 offset:1088
    ds_read_b64 v[70:71], v12 offset:1096
    s_waitcnt lgkmcnt(9)
    v_mfma_f32_16x16x32_f16 v[120:123], v[88:91], v[28:31], v[120:123]
    ds_read_b64 v[76:77], v12 offset:2112
    ds_read_b64 v[78:79], v12 offset:2120
    s_waitcnt lgkmcnt(10)
    v_mfma_f32_16x16x32_f16 v[124:127], v[16:19], v[32:35], v[124:127]
    ds_read_b128 v[72:75], v13 offset:1600
    s_waitcnt lgkmcnt(9)
    v_mfma_f32_16x16x32_f16 v[124:127], v[36:39], v[28:31], v[124:127]
    ds_read_b128 v[60:63], v13 offset:2112
    s_waitcnt lgkmcnt(8)
    v_mfma_f32_16x16x32_f16 v[116:119], v[48:51], v[84:87], v[116:119]
    ds_read_b64 v[56:57], v12 offset:1600
    ds_read_b64 v[58:59], v12 offset:1608
    s_waitcnt lgkmcnt(9)
    v_mfma_f32_16x16x32_f16 v[116:119], v[88:91], v[52:55], v[116:119]
    ds_read_b64 v[44:45], v12 offset:3712
    ds_read_b64 v[46:47], v12 offset:3720
    v_mfma_f32_16x16x32_f16 v[120:123], v[48:51], v[32:35], v[120:123]
    ds_read_b128 v[40:43], v13 offset:3712
    v_mfma_f32_16x16x32_f16 v[120:123], v[36:39], v[52:55], v[120:123]
    ds_read_b64 v[24:25], v12 offset:128
    ds_read_b64 v[26:27], v12 offset:136
    s_waitcnt lgkmcnt(13)
    v_mfma_f32_16x16x32_f16 v[124:127], v[48:51], v[64:67], v[124:127]
    v_and_b32 v141, 0xffff0000, v140
    s_waitcnt lgkmcnt(11)
    v_mfma_f32_16x16x32_f16 v[124:127], v[68:71], v[52:55], v[124:127]
    ds_read_b128 v[20:23], v13 offset:128
    s_waitcnt lgkmcnt(10)
    v_mfma_f32_16x16x32_f16 v[112:115], v[76:79], v[84:87], v[112:115]
    ds_read_b64 v[80:81], v12 offset:3200
    ds_read_b64 v[82:83], v12 offset:3208
    s_waitcnt lgkmcnt(11)
    v_mfma_f32_16x16x32_f16 v[112:115], v[88:91], v[72:75], v[112:115]
    ds_read_b128 v[92:95], v13 offset:640
    v_mfma_f32_16x16x32_f16 v[116:119], v[76:79], v[32:35], v[116:119]
    ds_read_b128 v[16:19], v13 offset:3200
    v_mfma_f32_16x16x32_f16 v[116:119], v[36:39], v[72:75], v[116:119]
    v_lshlrev_b32 v140, 16, v140
    v_mfma_f32_16x16x32_f16 v[120:123], v[76:79], v[64:67], v[120:123]
    v_and_b32 v143, 0xffff0000, v142
    v_mfma_f32_16x16x32_f16 v[120:123], v[68:71], v[72:75], v[120:123]
    v_lshlrev_b32 v142, 16, v142
    s_waitcnt lgkmcnt(12)
    v_mfma_f32_16x16x32_f16 v[124:127], v[76:79], v[60:63], v[124:127]
    ds_read_b64 v[28:29], v12 offset:640
    ds_read_b64 v[30:31], v12 offset:648
    s_waitcnt lgkmcnt(12)
    v_mfma_f32_16x16x32_f16 v[124:127], v[56:59], v[72:75], v[124:127]
    ds_read_b64 v[48:49], v12 offset:2688
    ds_read_b64 v[50:51], v12 offset:2696
    v_mfma_f32_16x16x32_f16 v[108:111], v[56:59], v[84:87], v[108:111]
    v_and_b32 v145, 0xffff0000, v144
    v_mfma_f32_16x16x32_f16 v[108:111], v[88:91], v[60:63], v[108:111]
    v_lshlrev_b32 v144, 16, v144
    v_mfma_f32_16x16x32_f16 v[112:115], v[56:59], v[32:35], v[112:115]
    v_and_b32 v147, 0xffff0000, v146
    v_mfma_f32_16x16x32_f16 v[112:115], v[36:39], v[60:63], v[112:115]
    v_lshlrev_b32 v146, 16, v146
    v_mfma_f32_16x16x32_f16 v[116:119], v[56:59], v[64:67], v[116:119]
    v_bfe_u32 v138, v1, 3, 2
    v_mfma_f32_16x16x32_f16 v[116:119], v[68:71], v[60:63], v[116:119]
    v_xor_b32 v138, v138, v1
    v_mfma_f32_16x16x32_f16 v[120:123], v[56:59], v[60:63], v[120:123]
    v_lshrrev_b32 v139, 8, v4
    v_mfma_f32_16x16x32_f16 v[104:107], v[68:71], v[84:87], v[104:107]
    v_lshlrev_b32 v139, 12, v139
    v_mfma_f32_16x16x32_f16 v[104:107], v[88:91], v[64:67], v[104:107]
    v_lshl_add_u32 v129, v138, 4, v139
    v_mfma_f32_16x16x32_f16 v[108:111], v[68:71], v[32:35], v[108:111]
    v_add_u32 v129, 0, v129
    v_mfma_f32_16x16x32_f16 v[108:111], v[36:39], v[64:67], v[108:111]
    s_lshl_b32 s58, s4, 13
    v_mfma_f32_16x16x32_f16 v[112:115], v[68:71], v[64:67], v[112:115]
    s_add_u32 s58, s58, 1048576
    v_mfma_f32_16x16x32_f16 v[100:103], v[36:39], v[84:87], v[100:103]
    v_lshl_add_u32 v130, v4, 2, s58
    v_mfma_f32_16x16x32_f16 v[100:103], v[88:91], v[32:35], v[100:103]
    s_lshl_b32 s58, s4, 7
    v_mfma_f32_16x16x32_f16 v[104:107], v[36:39], v[32:35], v[104:107]
    s_add_u32 s58, s58, 163840
    v_mfma_f32_16x16x32_f16 v[96:99], v[88:91], v[84:87], v[96:99]
    v_lshrrev_b32 v131, 6, v4
    s_waitcnt lgkmcnt(11)
    v_mfma_f32_16x16x32_f16 v[124:127], v[44:47], v[40:43], v[124:127]
    ds_read_b128 v[52:55], v13 offset:1152
    s_waitcnt lgkmcnt(9)
    v_mfma_f32_16x16x32_f16 v[124:127], v[24:27], v[20:23], v[124:127]
    ds_read_b128 v[76:79], v13 offset:2688
    s_waitcnt lgkmcnt(8)
    v_mfma_f32_16x16x32_f16 v[120:123], v[80:83], v[40:43], v[120:123]
    ds_read_b64 v[72:73], v12 offset:1152
    ds_read_b64 v[74:75], v12 offset:1160
    s_waitcnt lgkmcnt(9)
    v_mfma_f32_16x16x32_f16 v[120:123], v[24:27], v[92:95], v[120:123]
    ds_read_b64 v[56:57], v12 offset:2176
    ds_read_b64 v[58:59], v12 offset:2184
    s_waitcnt lgkmcnt(10)
    v_mfma_f32_16x16x32_f16 v[124:127], v[80:83], v[16:19], v[124:127]
    ds_read_b128 v[60:63], v13 offset:1664
    s_waitcnt lgkmcnt(9)
    v_mfma_f32_16x16x32_f16 v[124:127], v[28:31], v[92:95], v[124:127]
    ds_read_b128 v[68:71], v13 offset:2176
    s_waitcnt lgkmcnt(8)
    v_mfma_f32_16x16x32_f16 v[116:119], v[48:51], v[40:43], v[116:119]
    ds_read_b64 v[64:65], v12 offset:1664
    ds_read_b64 v[66:67], v12 offset:1672
    s_waitcnt lgkmcnt(9)
    v_mfma_f32_16x16x32_f16 v[116:119], v[24:27], v[52:55], v[116:119]
    ds_read_b64 v[36:37], v12 offset:192
    ds_read_b64 v[38:39], v12 offset:200
    v_mfma_f32_16x16x32_f16 v[120:123], v[48:51], v[16:19], v[120:123]
    ds_read_b128 v[32:35], v13 offset:3776
    v_mfma_f32_16x16x32_f16 v[120:123], v[28:31], v[52:55], v[120:123]
    ds_read_b128 v[88:91], v13 offset:3264
    s_waitcnt lgkmcnt(12)
    v_mfma_f32_16x16x32_f16 v[124:127], v[48:51], v[76:79], v[124:127]
    ds_read_b64 v[84:85], v12 offset:704
    ds_read_b64 v[86:87], v12 offset:712
    s_waitcnt lgkmcnt(12)
    v_mfma_f32_16x16x32_f16 v[124:127], v[72:75], v[52:55], v[124:127]
    ds_read_b128 v[44:47], v13 offset:2752
    s_waitcnt lgkmcnt(11)
    v_mfma_f32_16x16x32_f16 v[112:115], v[56:59], v[40:43], v[112:115]
    ds_read_b64 v[20:21], v12 offset:1216
    ds_read_b64 v[22:23], v12 offset:1224
    s_waitcnt lgkmcnt(12)
    v_mfma_f32_16x16x32_f16 v[112:115], v[24:27], v[60:63], v[112:115]
    ds_read_b128 v[80:83], v13 offset:2240
    v_mfma_f32_16x16x32_f16 v[116:119], v[56:59], v[16:19], v[116:119]
    v_lshl_add_u32 v131, v131, 2, s58
    v_mfma_f32_16x16x32_f16 v[116:119], v[28:31], v[60:63], v[116:119]
    v_lshrrev_b32 v138, 4, v0
    v_mfma_f32_16x16x32_f16 v[120:123], v[56:59], v[76:79], v[120:123]
    v_and_b32 v139, 15, v0
    v_mfma_f32_16x16x32_f16 v[120:123], v[72:75], v[60:63], v[120:123]
    s_lshl_b32 s58, s5, 18
    s_waitcnt lgkmcnt(12)
    v_mfma_f32_16x16x32_f16 v[124:127], v[56:59], v[68:71], v[124:127]
    ds_read_b64 v[92:93], v12 offset:1728
    ds_read_b64 v[94:95], v12 offset:1736
    s_waitcnt lgkmcnt(12)
    v_mfma_f32_16x16x32_f16 v[124:127], v[64:67], v[60:63], v[124:127]
    ds_read_b128 v[48:51], v13 offset:1728
    v_mfma_f32_16x16x32_f16 v[108:111], v[64:67], v[40:43], v[108:111]
    s_lshl_b32 s59, s6, 8
    v_mfma_f32_16x16x32_f16 v[108:111], v[24:27], v[68:71], v[108:111]
    s_add_u32 s58, s58, s59
    v_mfma_f32_16x16x32_f16 v[112:115], v[64:67], v[16:19], v[112:115]
    s_add_u32 s58, s58, 1048576
    v_mfma_f32_16x16x32_f16 v[112:115], v[28:31], v[68:71], v[112:115]
    v_lshlrev_b32 v132, 13, v138
    v_mfma_f32_16x16x32_f16 v[116:119], v[64:67], v[76:79], v[116:119]
    v_lshl_add_u32 v132, v139, 4, v132
    v_mfma_f32_16x16x32_f16 v[116:119], v[72:75], v[68:71], v[116:119]
    v_add_u32 v132, s58, v132
    v_mfma_f32_16x16x32_f16 v[120:123], v[64:67], v[68:71], v[120:123]
    s_lshl_b32 s58, s5, 12
    v_mfma_f32_16x16x32_f16 v[104:107], v[72:75], v[40:43], v[104:107]
    s_lshl_b32 s59, s6, 2
    v_mfma_f32_16x16x32_f16 v[104:107], v[24:27], v[76:79], v[104:107]
    s_add_u32 s58, s58, s59
    v_mfma_f32_16x16x32_f16 v[108:111], v[72:75], v[16:19], v[108:111]
    s_add_u32 s58, s58, 163840
    v_mfma_f32_16x16x32_f16 v[108:111], v[28:31], v[76:79], v[108:111]
    v_lshl_add_u32 v133, v138, 7, s58
    v_mfma_f32_16x16x32_f16 v[112:115], v[72:75], v[76:79], v[112:115]
    v_mul_u32_u24 v134, 528, v139
    v_mfma_f32_16x16x32_f16 v[100:103], v[28:31], v[40:43], v[100:103]
    v_lshl_add_u32 v134, v138, 2, v134
    v_mfma_f32_16x16x32_f16 v[100:103], v[24:27], v[16:19], v[100:103]
    v_add_u32 v134, 124608, v134
    v_mfma_f32_16x16x32_f16 v[104:107], v[28:31], v[16:19], v[104:107]
    v_lshrrev_b32 v137, 3, v0
    v_mfma_f32_16x16x32_f16 v[96:99], v[24:27], v[40:43], v[96:99]
    v_and_b32 v139, 7, v0
    s_waitcnt lgkmcnt(10)
    v_mfma_f32_16x16x32_f16 v[96:99], v[36:39], v[32:35], v[96:99]
    ds_read_b64 v[52:53], v12 offset:2240
    ds_read_b64 v[54:55], v12 offset:2248
    s_waitcnt lgkmcnt(11)
    v_mfma_f32_16x16x32_f16 v[100:103], v[36:39], v[88:91], v[100:103]
    ds_read_b128 v[56:59], v13 offset:1216
    s_waitcnt lgkmcnt(10)
    v_mfma_f32_16x16x32_f16 v[100:103], v[84:87], v[32:35], v[100:103]
    ds_read_b64 v[60:61], v12 offset:2752
    ds_read_b64 v[62:63], v12 offset:2760
    s_waitcnt lgkmcnt(11)
    v_mfma_f32_16x16x32_f16 v[104:107], v[36:39], v[44:47], v[104:107]
    ds_read_b128 v[64:67], v13 offset:704
    v_mfma_f32_16x16x32_f16 v[104:107], v[84:87], v[88:91], v[104:107]
    ds_write_b128 v14, v[96:99] offset:0
    s_mov_b64 exec, 1
    ds_add_u32 v10, v11 offset:0
    s_mov_b64 exec, -1
    s_waitcnt lgkmcnt(12)
    v_mfma_f32_16x16x32_f16 v[104:107], v[20:23], v[32:35], v[104:107]
    ds_read_b64 v[68:69], v12 offset:3264
    ds_read_b64 v[70:71], v12 offset:3272
    s_waitcnt lgkmcnt(13)
    v_mfma_f32_16x16x32_f16 v[108:111], v[36:39], v[80:83], v[108:111]
    ds_write_b128 v14, v[100:103] offset:4096
    s_mov_b64 exec, 1
    ds_add_u32 v10, v11 offset:4
    s_mov_b64 exec, -1
    v_mfma_f32_16x16x32_f16 v[108:111], v[84:87], v[44:47], v[108:111]
    v_mul_u32_u24 v135, 132, v137
    v_mfma_f32_16x16x32_f16 v[108:111], v[20:23], v[88:91], v[108:111]
    v_lshl_add_u32 v135, v139, 4, v135
    s_waitcnt lgkmcnt(13)
    v_mfma_f32_16x16x32_f16 v[108:111], v[92:95], v[32:35], v[108:111]
    ds_write_b128 v14, v[104:107] offset:8192
    s_mov_b64 exec, 1
    ds_add_u32 v10, v11 offset:8
    s_mov_b64 exec, -1
    s_waitcnt lgkmcnt(14)
    v_mfma_f32_16x16x32_f16 v[112:115], v[36:39], v[48:51], v[112:115]
    s_lshl_b32 s58, s6, 6
    v_mfma_f32_16x16x32_f16 v[112:115], v[84:87], v[80:83], v[112:115]
    v_add_u32 v137, s58, v137
    v_mfma_f32_16x16x32_f16 v[112:115], v[20:23], v[44:47], v[112:115]
    v_lshlrev_b32 v136, 10, v137
    v_mfma_f32_16x16x32_f16 v[112:115], v[92:95], v[88:91], v[112:115]
    ds_write_b128 v14, v[108:111] offset:12288
    s_mov_b64 exec, 1
    ds_add_u32 v10, v11 offset:12
    s_mov_b64 exec, -1
    s_waitcnt lgkmcnt(14)
    v_mfma_f32_16x16x32_f16 v[112:115], v[52:55], v[32:35], v[112:115]
    v_lshl_add_u32 v136, v139, 4, v136
    s_waitcnt lgkmcnt(13)
    v_mfma_f32_16x16x32_f16 v[116:119], v[36:39], v[56:59], v[116:119]
    s_lshl_b32 s58, s5, 7
    v_mfma_f32_16x16x32_f16 v[116:119], v[84:87], v[48:51], v[116:119]
    v_add_u32 v136, s58, v136
    v_mfma_f32_16x16x32_f16 v[116:119], v[20:23], v[80:83], v[116:119]
    v_mfma_f32_16x16x32_f16 v[116:119], v[92:95], v[44:47], v[116:119]
    ds_write_b128 v14, v[112:115] offset:16384
    s_mov_b64 exec, 1
    ds_add_u32 v10, v11 offset:16
    s_mov_b64 exec, -1
    v_mfma_f32_16x16x32_f16 v[116:119], v[52:55], v[88:91], v[116:119]
    s_waitcnt lgkmcnt(13)
    v_mfma_f32_16x16x32_f16 v[116:119], v[60:63], v[32:35], v[116:119]
    s_waitcnt lgkmcnt(12)
    v_mfma_f32_16x16x32_f16 v[120:123], v[36:39], v[64:67], v[120:123]
    ds_read_b128 v[72:75], v13 offset:192
    v_mfma_f32_16x16x32_f16 v[120:123], v[84:87], v[56:59], v[120:123]
    v_mfma_f32_16x16x32_f16 v[120:123], v[20:23], v[48:51], v[120:123]
    v_mfma_f32_16x16x32_f16 v[120:123], v[92:95], v[80:83], v[120:123]
    s_nop 1
    ds_write_b128 v14, v[116:119] offset:20480
    s_mov_b64 exec, 1
    ds_add_u32 v10, v11 offset:20
    s_mov_b64 exec, -1
    v_mfma_f32_16x16x32_f16 v[120:123], v[52:55], v[44:47], v[120:123]
    v_mfma_f32_16x16x32_f16 v[120:123], v[60:63], v[88:91], v[120:123]
    s_waitcnt lgkmcnt(11)
    v_mfma_f32_16x16x32_f16 v[120:123], v[68:71], v[32:35], v[120:123]
    ds_read_b64 v[76:77], v12 offset:3776
    ds_read_b64 v[78:79], v12 offset:3784
    s_waitcnt lgkmcnt(4)
    v_mfma_f32_16x16x32_f16 v[124:127], v[36:39], v[72:75], v[124:127]
    v_mfma_f32_16x16x32_f16 v[124:127], v[84:87], v[64:67], v[124:127]
    v_mfma_f32_16x16x32_f16 v[124:127], v[20:23], v[56:59], v[124:127]
    v_mfma_f32_16x16x32_f16 v[124:127], v[92:95], v[48:51], v[124:127]
    s_nop 0
    ds_write_b128 v14, v[120:123] offset:24576
    s_mov_b64 exec, 1
    ds_add_u32 v10, v11 offset:24
    s_mov_b64 exec, -1
    v_mfma_f32_16x16x32_f16 v[124:127], v[52:55], v[80:83], v[124:127]
    v_mfma_f32_16x16x32_f16 v[124:127], v[60:63], v[44:47], v[124:127]
    v_mfma_f32_16x16x32_f16 v[124:127], v[68:71], v[88:91], v[124:127]
    s_waitcnt lgkmcnt(2)
    v_mfma_f32_16x16x32_f16 v[124:127], v[76:79], v[32:35], v[124:127]
    s_nop 7
    ds_write_b128 v14, v[124:127] offset:28672
    s_mov_b64 exec, 1
    ds_add_u32 v10, v11 offset:28
    s_mov_b64 exec, -1
    s_setprio 0
    s_add_u32 s14, s3, 4
    s_branch L_EPI
L_AUX:
    s_waitcnt lgkmcnt(0)
    s_barrier
    v_lshlrev_b32 v148, 16, v164
    v_and_b32 v149, 0xffff0000, v164
    v_lshlrev_b32 v150, 16, v165
    v_and_b32 v151, 0xffff0000, v165
    v_lshlrev_b32 v152, 16, v166
    v_and_b32 v153, 0xffff0000, v166
    v_lshlrev_b32 v154, 16, v167
    v_and_b32 v155, 0xffff0000, v167
    v_mul_f32 v140, v148, v156
    v_mul_f32 v141, v149, v157
    v_mul_f32 v142, v150, v156
    v_mul_f32 v143, v151, v157
    v_mul_f32 v144, v152, v156
    v_mul_f32 v145, v153, v157
    v_mul_f32 v146, v154, v156
    v_mul_f32 v147, v155, v157
    v_cvt_pk_bf16_f32 v140, v140, v141
    v_cvt_pk_bf16_f32 v142, v142, v143
    v_cvt_pk_bf16_f32 v144, v144, v145
    v_cvt_pk_bf16_f32 v146, v146, v147
    v_and_b32 v141, 0xffff0000, v140
    v_lshlrev_b32 v140, 16, v140
    v_and_b32 v143, 0xffff0000, v142
    v_lshlrev_b32 v142, 16, v142
    v_and_b32 v145, 0xffff0000, v144
    v_lshlrev_b32 v144, 16, v144
    v_and_b32 v147, 0xffff0000, v146
    v_lshlrev_b32 v146, 16, v146
    v_bfe_u32 v138, v1, 3, 2
    v_xor_b32 v138, v138, v1
    v_lshrrev_b32 v139, 8, v4
    v_lshlrev_b32 v139, 12, v139
    v_lshl_add_u32 v129, v138, 4, v139
    v_add_u32 v129, 0, v129
    s_lshl_b32 s58, s4, 13
    s_add_u32 s58, s58, 1048576
    v_lshl_add_u32 v130, v4, 2, s58
    s_lshl_b32 s58, s4, 7
    s_add_u32 s58, s58, 163840
    v_lshrrev_b32 v131, 6, v4
    v_lshl_add_u32 v131, v131, 2, s58
    v_lshrrev_b32 v138, 4, v0
    v_and_b32 v139, 15, v0
    s_lshl_b32 s58, s5, 18
    s_lshl_b32 s59, s6, 8
    s_add_u32 s58, s58, s59
    s_add_u32 s58, s58, 1048576
    v_lshlrev_b32 v132, 13, v138
    v_lshl_add_u32 v132, v139, 4, v132
    v_add_u32 v132, s58, v132
    s_lshl_b32 s58, s5, 12
    s_lshl_b32 s59, s6, 2
    s_add_u32 s58, s58, s59
    s_add_u32 s58, s58, 163840
    v_lshl_add_u32 v133, v138, 7, s58
    v_mul_u32_u24 v134, 528, v139
    v_lshl_add_u32 v134, v138, 2, v134
    v_add_u32 v134, 124608, v134
    v_lshrrev_b32 v137, 3, v0
    v_and_b32 v139, 7, v0
    v_mul_u32_u24 v135, 132, v137
    v_lshl_add_u32 v135, v139, 4, v135
    s_lshl_b32 s58, s6, 6
    v_add_u32 v137, s58, v137
    v_lshlrev_b32 v136, 10, v137
    v_lshl_add_u32 v136, v139, 4, v136
    s_lshl_b32 s58, s5, 7
    v_add_u32 v136, s58, v136
    s_sub_u32 s14, s3, 4
    v_mov_b32 v10, 124560
    s_mov_b32 s62, 0
LW_T0:
    ds_read_b32 v11, v10
    s_add_u32 s62, s62, 1
    s_waitcnt lgkmcnt(0)
    v_readfirstlane_b32 s63, v11
    s_cmp_ge_u32 s63, 1
    s_cbranch_scc1 LWD_T0
    s_sleep 4
    s_cmp_lt_u32 s62, 262144
    s_cbranch_scc1 LW_T0
LWD_T0:
    s_lshl_b32 s13, s14, 2
    s_add_u32 s13, s13, 124560
    v_mov_b32 v10, s13
    s_mov_b32 s62, 0
LW_T1:
    ds_read_b32 v11, v10
    s_add_u32 s62, s62, 1
    s_waitcnt lgkmcnt(0)
    v_readfirstlane_b32 s63, v11
    s_cmp_ge_u32 s63, 4
    s_cbranch_scc1 LWD_T1
    s_sleep 1
    s_cmp_lt_u32 s62, 262144
    s_cbranch_scc1 LW_T1
LWD_T1:
L_EPI:
    s_lshl_b32 s13, s14, 2
    s_add_u32 s13, s13, 124560
    v_mov_b32 v6, s13
    v_mov_b32 v7, 124496
    s_mov_b32 s62, 0
EP_RD:
    ds_read_b32 v30, v6
    ds_read_b32 v31, v7 offset:40
    ds_read_b128 v[24:27], v7
    ds_read_b32 v5, v7 offset:48
    ds_read_b128 v[8:11], v129
    ds_read_b128 v[12:15], v129 offset:1024
    ds_read_b128 v[16:19], v129 offset:2048
    ds_read_b128 v[20:23], v129 offset:3072
    v_mov_b32 v28, 0x3a000000
    v_mov_b32 v29, 0x3a000000
    v_and_b32 v82, 15, v1
    v_lshl_add_u32 v82, v82, 1, 1
    v_lshlrev_b32 v48, 16, v160
    v_and_b32 v49, 0xffff0000, v160
    v_lshlrev_b32 v50, 16, v161
    v_and_b32 v51, 0xffff0000, v161
    v_lshlrev_b32 v52, 16, v162
    v_and_b32 v53, 0xffff0000, v162
    v_lshlrev_b32 v54, 16, v163
    v_and_b32 v55, 0xffff0000, v163
    s_waitcnt lgkmcnt(4)
    v_readfirstlane_b32 s50, v30
    v_readfirstlane_b32 s51, v31
    v_readfirstlane_b32 s8, v26
    v_readfirstlane_b32 s9, v27
    v_readfirstlane_b32 s12, v5
    s_add_u32 s62, s62, 1
    s_cmp_ge_u32 s50, 4
    s_cselect_b32 s52, 1, 0
    s_cmp_ge_u32 s51, 1
    s_cselect_b32 s53, s52, 0
    s_cmp_ge_u32 s62, 262144
    s_cselect_b32 s53, 1, s53
    s_cmp_eq_u32 s53, 1
    s_cbranch_scc1 EP_GO
    s_waitcnt lgkmcnt(0)
    s_branch EP_RD
EP_GO:
    s_waitcnt lgkmcnt(2)
    v_add_f32 v60, v8, v12
    v_add_f32 v62, v9, v13
    v_add_f32 v64, v10, v14
    v_add_f32 v66, v11, v15
    s_waitcnt lgkmcnt(0)
    v_add_f32 v61, v16, v20
    v_add_f32 v63, v17, v21
    v_add_f32 v65, v18, v22
    v_add_f32 v67, v19, v23
    v_pk_mul_f32 v[60:61], v[60:61], v[24:25]
    v_pk_mul_f32 v[62:63], v[62:63], v[24:25]
    v_pk_mul_f32 v[64:65], v[64:65], v[24:25]
    v_pk_mul_f32 v[66:67], v[66:67], v[24:25]
    v_cvt_pk_bf16_f32 v56, v60, v61
    v_cvt_pk_bf16_f32 v57, v62, v63
    v_cvt_pk_bf16_f32 v58, v64, v65
    v_cvt_pk_bf16_f32 v59, v66, v67
    v_lshlrev_b32 v60, 16, v56
    v_and_b32 v61, 0xffff0000, v56
    v_lshlrev_b32 v62, 16, v57
    v_and_b32 v63, 0xffff0000, v57
    v_lshlrev_b32 v64, 16, v58
    v_and_b32 v65, 0xffff0000, v58
    v_lshlrev_b32 v66, 16, v59
    v_and_b32 v67, 0xffff0000, v59
    v_pk_add_f32 v[60:61], v[60:61], v[140:141]
    v_pk_add_f32 v[62:63], v[62:63], v[142:143]
    v_pk_add_f32 v[64:65], v[64:65], v[144:145]
    v_pk_add_f32 v[66:67], v[66:67], v[146:147]
    v_cvt_pk_bf16_f32 v56, v60, v61
    v_cvt_pk_bf16_f32 v57, v62, v63
    v_cvt_pk_bf16_f32 v58, v64, v65
    v_cvt_pk_bf16_f32 v59, v66, v67
    v_lshlrev_b32 v60, 16, v56
    v_and_b32 v61, 0xffff0000, v56
    v_lshlrev_b32 v62, 16, v57
    v_and_b32 v63, 0xffff0000, v57
    v_lshlrev_b32 v64, 16, v58
    v_and_b32 v65, 0xffff0000, v58
    v_lshlrev_b32 v66, 16, v59
    v_and_b32 v67, 0xffff0000, v59
    v_pk_add_f32 v[60:61], v[60:61], v[48:49]
    v_pk_add_f32 v[62:63], v[62:63], v[50:51]
    v_pk_add_f32 v[64:65], v[64:65], v[52:53]
    v_pk_add_f32 v[66:67], v[66:67], v[54:55]
    v_cvt_pk_bf16_f32 v56, v60, v61
    v_cvt_pk_bf16_f32 v57, v62, v63
    v_cvt_pk_bf16_f32 v58, v64, v65
    v_cvt_pk_bf16_f32 v59, v66, v67
    v_lshlrev_b32 v60, 16, v56
    v_and_b32 v61, 0xffff0000, v56
    v_lshlrev_b32 v62, 16, v57
    v_and_b32 v63, 0xffff0000, v57
    v_lshlrev_b32 v64, 16, v58
    v_and_b32 v65, 0xffff0000, v58
    v_lshlrev_b32 v66, 16, v59
    v_and_b32 v67, 0xffff0000, v59
    v_pk_fma_f32 v[60:61], v[148:149], v[28:29], v[60:61]
    v_pk_fma_f32 v[62:63], v[150:151], v[28:29], v[62:63]
    v_pk_fma_f32 v[64:65], v[152:153], v[28:29], v[64:65]
    v_pk_fma_f32 v[66:67], v[154:155], v[28:29], v[66:67]
    v_cvt_pk_bf16_f32 v68, v60, v61
    v_cvt_pk_bf16_f32 v69, v62, v63
    v_cvt_pk_bf16_f32 v70, v64, v65
    v_cvt_pk_bf16_f32 v71, v66, v67
    s_cmp_lg_u32 s12, 0
    s_cbranch_scc1 EP_NOX
    global_store_dwordx4 v130, v[68:71], s[48:49]
    v_alignbit_b32 v9, v69, v69, 25
    v_alignbit_b32 v10, v70, v70, 19
    v_alignbit_b32 v8, v71, v71, 10
    v_add3_u32 v9, v9, v10, v68
    v_add_u32 v8, v8, v9
    v_mul_lo_u32 v8, v8, v82
    s_nop 1
    v_add_u32_dpp v8, v8, v8 quad_perm:[1,0,3,2] row_mask:0xf bank_mask:0xf
    s_nop 1
    v_add_u32_dpp v8, v8, v8 quad_perm:[2,3,0,1] row_mask:0xf bank_mask:0xf
    s_nop 1
    v_add_u32_dpp v8, v8, v8 row_half_mirror row_mask:0xf bank_mask:0xf
    s_nop 1
    v_add_u32_dpp v8, v8, v8 row_mirror row_mask:0xf bank_mask:0xf
    v_add_u32 v8, s10, v8
    s_mov_b32 exec_lo, 0x00010001
    s_mov_b32 exec_hi, 0x00010001
    global_store_dword v131, v8, s[48:49]
    s_mov_b64 exec, -1
EP_NOX:
    s_lshr_b32 s50, s8, 8
    s_lshr_b32 s51, s9, 8
    s_cmp_eq_u32 s50, s14
    s_cselect_b32 s52, 1, 0
    s_cmp_eq_u32 s51, s14
    s_cselect_b32 s53, 1, 0
    s_or_b32 s54, s52, s53
    s_cmp_eq_u32 s54, 0
    s_cbranch_scc1 EP_NOSEL
    s_lshl_b32 s55, s4, 4
    s_add_u32 s55, s55, 65536
    v_mov_b32 v74, 0
    v_mov_b32 v75, s10
    v_add_u32 v7, 0, v4
    v_cmp_eq_u32 s[50:51], s8, v7
    v_cmp_eq_u32 s[52:53], s9, v7
    v_mov_b32 v72, v56
    v_mov_b32 v73, v164
    v_mov_b32 v76, s55
    v_mov_b32 v77, 0x1000
    s_or_b64 s[56:57], s[50:51], s[52:53]
    v_cndmask_b32 v77, 0, v77, s[52:53]
    v_add_u32 v76, v76, v77
    s_mov_b64 exec, s[56:57]
    s_cbranch_execz EPN_0
    global_store_dwordx4 v76, v[72:75], s[48:49] sc0 sc1
EPN_0:
    s_mov_b64 exec, -1
    s_nop 1
    v_add_u32 v7, 1, v4
    v_cmp_eq_u32 s[50:51], s8, v7
    v_cmp_eq_u32 s[52:53], s9, v7
    v_mov_b32 v72, v57
    v_mov_b32 v73, v165
    v_mov_b32 v76, s55
    v_mov_b32 v77, 0x1000
    s_or_b64 s[56:57], s[50:51], s[52:53]
    v_cndmask_b32 v77, 0, v77, s[52:53]
    v_add_u32 v76, v76, v77
    s_mov_b64 exec, s[56:57]
    s_cbranch_execz EPN_1
    global_store_dwordx4 v76, v[72:75], s[48:49] sc0 sc1
EPN_1:
    s_mov_b64 exec, -1
    s_nop 1
    v_add_u32 v7, 2, v4
    v_cmp_eq_u32 s[50:51], s8, v7
    v_cmp_eq_u32 s[52:53], s9, v7
    v_mov_b32 v72, v58
    v_mov_b32 v73, v166
    v_mov_b32 v76, s55
    v_mov_b32 v77, 0x1000
    s_or_b64 s[56:57], s[50:51], s[52:53]
    v_cndmask_b32 v77, 0, v77, s[52:53]
    v_add_u32 v76, v76, v77
    s_mov_b64 exec, s[56:57]
    s_cbranch_execz EPN_2
    global_store_dwordx4 v76, v[72:75], s[48:49] sc0 sc1
EPN_2:
    s_mov_b64 exec, -1
    s_nop 1
    v_add_u32 v7, 3, v4
    v_cmp_eq_u32 s[50:51], s8, v7
    v_cmp_eq_u32 s[52:53], s9, v7
    v_mov_b32 v72, v59
    v_mov_b32 v73, v167
    v_mov_b32 v76, s55
    v_mov_b32 v77, 0x1000
    s_or_b64 s[56:57], s[50:51], s[52:53]
    v_cndmask_b32 v77, 0, v77, s[52:53]
    v_add_u32 v76, v76, v77
    s_mov_b64 exec, s[56:57]
    s_cbranch_execz EPN_3
    global_store_dwordx4 v76, v[72:75], s[48:49] sc0 sc1
EPN_3:
    s_mov_b64 exec, -1
    s_nop 1
EP_NOSEL:
    s_cmp_lg_u32 s12, 0
    s_cbranch_scc1 EP_SCAT
    v_mov_b32 v10, 124588
    s_mov_b32 s62, 0
LW_C:
    ds_read_b32 v11, v10
    s_add_u32 s62, s62, 1
    s_waitcnt lgkmcnt(0)
    v_readfirstlane_b32 s63, v11
    s_cmp_ge_u32 s63, 4
    s_cbranch_scc1 LWD_C
    s_sleep 1
    s_cmp_lt_u32 s62, 262144
    s_cbranch_scc1 LW_C
LWD_C:
    s_mov_b32 s62, 0
EP_POLL:
    global_load_dwordx4 v[8:11], v132, s[48:49] sc1
    global_load_dword v12, v133, s[48:49] sc1
    s_mov_b64 exec, -1
    s_waitcnt vmcnt(0)
    v_alignbit_b32 v14, v9, v9, 25
    v_alignbit_b32 v15, v10, v10, 19
    v_alignbit_b32 v13, v11, v11, 10
    v_add3_u32 v14, v14, v15, v8
    v_add_u32 v13, v13, v14
    v_mul_lo_u32 v13, v13, v82
    s_nop 1
    v_add_u32_dpp v13, v13, v13 quad_perm:[1,0,3,2] row_mask:0xf bank_mask:0xf
    s_nop 1
    v_add_u32_dpp v13, v13, v13 quad_perm:[2,3,0,1] row_mask:0xf bank_mask:0xf
    s_nop 1
    v_add_u32_dpp v13, v13, v13 row_half_mirror row_mask:0xf bank_mask:0xf
    s_nop 1
    v_add_u32_dpp v13, v13, v13 row_mirror row_mask:0xf bank_mask:0xf
    v_add_u32 v13, s10, v13
    v_cmp_ne_u32 vcc, v13, v12
    s_cbranch_vccz EP_GOT
    s_add_u32 s62, s62, 1
    s_mov_b64 exec, vcc
    s_cmp_lt_u32 s62, 262144
    s_cbranch_scc1 EP_POLL
    s_mov_b64 exec, -1
EP_GOT:
    ds_write_b32 v134, v8 offset:0
    ds_write_b32 v134, v9 offset:132
    ds_write_b32 v134, v10 offset:264
    ds_write_b32 v134, v11 offset:396
    s_waitcnt lgkmcnt(0)
    v_mov_b32 v14, 124524
    v_mov_b32 v15, 1
    s_mov_b64 exec, 1
    ds_add_u32 v14, v15
    s_mov_b64 exec, -1
    s_mov_b32 s62, 0
LB_1:
    ds_read_b32 v15, v14
    s_add_u32 s62, s62, 1
    s_waitcnt lgkmcnt(0)
    v_readfirstlane_b32 s63, v15
    s_cmp_ge_u32 s63, 8
    s_cbranch_scc1 LBD_1
    s_cmp_lt_u32 s62, 262144
    s_cbranch_scc1 LB_1
LBD_1:
    v_add_u32 v135, 124608, v135
    ds_read2_b32 v[8:9], v135 offset0:0 offset1:1
    ds_read2_b32 v[10:11], v135 offset0:2 offset1:3
    v_cmp_ne_u32 vcc, s8, v137
    v_cmp_ne_u32 s[50:51], s9, v137
    s_and_b64 exec, vcc, s[50:51]
    s_waitcnt lgkmcnt(0)
    global_store_dwordx4 v136, v[8:11], s[44:45] sc0 sc1
    s_mov_b64 exec, -1
    s_branch EP_DONE
EP_SCAT:
    v_add_u32 v7, 0, v4
    v_cmp_ne_u32 vcc, s8, v7
    v_cmp_ne_u32 s[50:51], s9, v7
    s_and_b64 exec, vcc, s[50:51]
    global_store_dword v3, v68, s[44:45] offset:0
    s_mov_b64 exec, -1
    v_add_u32 v7, 1, v4
    v_cmp_ne_u32 vcc, s8, v7
    v_cmp_ne_u32 s[50:51], s9, v7
    s_and_b64 exec, vcc, s[50:51]
    global_store_dword v3, v69, s[44:45] offset:1024
    s_mov_b64 exec, -1
    v_add_u32 v7, 2, v4
    v_cmp_ne_u32 vcc, s8, v7
    v_cmp_ne_u32 s[50:51], s9, v7
    s_and_b64 exec, vcc, s[50:51]
    global_store_dword v3, v70, s[44:45] offset:2048
    s_mov_b64 exec, -1
    v_add_u32 v7, 3, v4
    v_cmp_ne_u32 vcc, s8, v7
    v_cmp_ne_u32 s[50:51], s9, v7
    s_and_b64 exec, vcc, s[50:51]
    global_store_dword v3, v71, s[44:45] offset:3072
    s_mov_b64 exec, -1
EP_DONE:
    s_lshl_b32 s50, s2, 4
    s_add_u32 s50, s50, s3
    s_cmp_eq_u32 s50, 4
    s_cbranch_scc0 L_NOEP
    v_mov_b32 v8, 196608
    v_mov_b32 v9, s10
    s_mov_b64 exec, 1
    global_store_dword v8, v9, s[48:49] sc0 sc1
    s_mov_b64 exec, -1
L_NOEP:
    s_endpgm
L_MOE:
    v_subrev_u32 v20, 512, v0
    v_lshrrev_b32 v106, 5, v20
    v_and_b32 v22, 31, v20
    s_lshl_b32 s14, s6, 4
    v_add_u32 v106, s14, v106
    v_mul_u32_u24 v106, 3584, v106
    v_min_u32 v22, 27, v22
    v_lshl_add_u32 v106, v22, 4, v106
    s_mul_i32 s14, s5, 448
    v_add_u32 v106, s14, v106
    v_add_u32 v107, 28672, v106
    v_lshrrev_b32 v108, 3, v20
    s_mul_i32 s14, s6, 56
    v_add_u32 v108, s14, v108
    v_lshlrev_b32 v108, 10, v108
    v_and_b32 v22, 7, v20
    v_lshl_add_u32 v108, v22, 4, v108
    s_lshl_b32 s14, s5, 7
    v_add_u32 v108, s14, v108
    v_add_u32 v109, 24576, v108
    s_waitcnt lgkmcnt(0)
    s_lshl_b32 s57, s7, 4
    s_lshr_b32 s56, s56, s57
    s_lshl_b32 s56, s56, 16
    v_mov_b32 v24, 0x3fb8aa3b
    v_mul_f32 v24, s56, v24
    v_exp_f32 v24, v24
    s_lshl_b32 s58, s13, 4
    s_sub_u32 s59, 16, s58
    s_lshl_b32 s60, s13, 8
    s_mul_i32 s61, s7, 34816
    s_add_u32 s60, s60, s61
    v_lshlrev_b32 v28, 2, v1
    v_add_u32 v28, s60, v28
    v_cvt_pk_bf16_f32 v24, v24, v24
    v_lshlrev_b32 v24, 16, v24
    s_waitcnt vmcnt(1)
    global_load_dwordx4 v[144:147], v106, s[38:39]
    global_load_dwordx4 v[148:151], v106, s[40:41]
    global_load_dwordx4 v[152:155], v107, s[38:39]
    global_load_dwordx4 v[156:159], v107, s[40:41]
    v_lshrrev_b32 v26, s58, v100
    v_lshrrev_b32 v27, s58, v101
    v_lshlrev_b32 v26, 16, v26
    v_lshlrev_b32 v27, 16, v27
    v_mul_f32 v26, v24, v26
    v_mul_f32 v27, v24, v27
    v_mul_f32 v26, 0x3fb8aa3b, v26
    v_mul_f32 v27, 0.15915494, v27
    v_lshrrev_b32 v36, s58, v102
    v_lshrrev_b32 v37, s58, v103
    v_lshrrev_b32 v38, s58, v104
    v_lshrrev_b32 v39, s58, v105
    v_lshlrev_b32 v36, 16, v36
    v_lshlrev_b32 v37, 16, v37
    v_lshlrev_b32 v38, 16, v38
    v_lshlrev_b32 v39, 16, v39
    v_mul_f32 v36, v24, v36
    v_mul_f32 v37, v24, v37
    v_pk_mul_f32 v[40:41], v[38:39], v[36:37] op_sel:[0,0] op_sel_hi:[0,1]
    v_pk_fma_f32 v[32:33], v[38:39], v[36:37], v[40:41] op_sel:[1,1,0] op_sel_hi:[1,0,1] neg_lo:[1,0,0]
    v_lshrrev_b32 v36, s59, v102
    v_lshrrev_b32 v37, s59, v103
    v_lshrrev_b32 v38, s59, v104
    v_lshrrev_b32 v39, s59, v105
    v_lshlrev_b32 v36, 16, v36
    v_lshlrev_b32 v37, 16, v37
    v_lshlrev_b32 v38, 16, v38
    v_lshlrev_b32 v39, 16, v39
    v_mul_f32 v36, v24, v36
    v_mul_f32 v37, v24, v37
    v_pk_mul_f32 v[40:41], v[38:39], v[36:37] op_sel:[0,0] op_sel_hi:[0,1]
    v_pk_fma_f32 v[34:35], v[38:39], v[36:37], v[40:41] op_sel:[1,1,0] op_sel_hi:[1,0,1] neg_lo:[1,0,0]
    v_max3_f32 v36, |v32|, |v33|, |v34|
    v_max_f32 v36, v36, |v35|
    v_exp_f32 v46, v26
    v_fract_f32 v47, v27
    v_cos_f32 v42, v47
    v_sin_f32 v43, v47
    v_mul_f32 v42, v46, v42
    v_mul_f32 v43, v46, v43
    v_mul_f32 v48, 0x43800000, v26
    v_mul_f32 v49, 0x43800000, v27
    v_exp_f32 v48, v48
    v_fract_f32 v49, v49
    v_cos_f32 v44, v49
    v_sin_f32 v45, v49
    v_mul_f32 v44, v48, v44
    v_mul_f32 v45, v48, v45
    v_max_f32_dpp v36, v36, v36 quad_perm:[1,0,3,2] row_mask:0xf bank_mask:0xf
    s_nop 1
    v_max_f32_dpp v36, v36, v36 quad_perm:[2,3,0,1] row_mask:0xf bank_mask:0xf
    s_nop 1
    v_max_f32_dpp v36, v36, v36 row_half_mirror row_mask:0xf bank_mask:0xf
    s_nop 1
    v_max_f32_dpp v36, v36, v36 row_mirror row_mask:0xf bank_mask:0xf
    s_nop 1
    v_max_f32_dpp v36, v36, v36 row_bcast:15 row_mask:0xa bank_mask:0xf
    s_nop 1
    v_max_f32_dpp v36, v36, v36 row_bcast:31 row_mask:0xc bank_mask:0xf
    s_nop 0
    v_readlane_b32 s62, v36, 63
    s_nop 1
    v_frexp_exp_i32_f32 v36, s62
    v_sub_u32 v37, 2, v36
    v_ldexp_f32 v50, v32, v37
    v_ldexp_f32 v51, v33, v37
    v_subrev_u32 v36, 13, v36
    v_ldexp_f32 v36, 1.0, v36
    s_lshl_b32 s62, s7, 2
    s_add_u32 s62, s62, 124496
    v_mov_b32 v37, s62
    ds_write_b32 v37, v36
    v_cvt_pk_f16_f32 v94, v50, -v51
    ds_write_b32 v28, v94 offset:0
    v_pk_mul_f32 v[70:71], v[50:51], v[44:45] op_sel:[0,0] op_sel_hi:[0,1]
    v_pk_fma_f32 v[70:71], v[50:51], v[44:45], v[70:71] op_sel:[1,1,0] op_sel_hi:[1,0,1] neg_lo:[1,0,0]
    v_pk_mul_f32 v[52:53], v[50:51], v[42:43] op_sel:[0,0] op_sel_hi:[0,1]
    v_pk_fma_f32 v[52:53], v[50:51], v[42:43], v[52:53] op_sel:[1,1,0] op_sel_hi:[1,0,1] neg_lo:[1,0,0]
    v_cvt_pk_f16_f32 v95, v70, -v71
    ds_write_b32 v28, v95 offset:4352
    v_cvt_pk_f16_f32 v96, v52, -v53
    ds_write_b32 v28, v96 offset:544
    v_pk_mul_f32 v[68:69], v[70:71], v[44:45] op_sel:[0,0] op_sel_hi:[0,1]
    v_pk_fma_f32 v[68:69], v[70:71], v[44:45], v[68:69] op_sel:[1,1,0] op_sel_hi:[1,0,1] neg_lo:[1,0,0]
    v_pk_mul_f32 v[54:55], v[52:53], v[42:43] op_sel:[0,0] op_sel_hi:[0,1]
    v_pk_fma_f32 v[54:55], v[52:53], v[42:43], v[54:55] op_sel:[1,1,0] op_sel_hi:[1,0,1] neg_lo:[1,0,0]
    v_cvt_pk_f16_f32 v97, v68, -v69
    ds_write_b32 v28, v97 offset:8704
    v_cvt_pk_f16_f32 v92, v54, -v55
    ds_write_b32 v28, v92 offset:1088
    v_pk_mul_f32 v[70:71], v[68:69], v[44:45] op_sel:[0,0] op_sel_hi:[0,1]
    v_pk_fma_f32 v[70:71], v[68:69], v[44:45], v[70:71] op_sel:[1,1,0] op_sel_hi:[1,0,1] neg_lo:[1,0,0]
    v_pk_mul_f32 v[56:57], v[54:55], v[42:43] op_sel:[0,0] op_sel_hi:[0,1]
    v_pk_fma_f32 v[56:57], v[54:55], v[42:43], v[56:57] op_sel:[1,1,0] op_sel_hi:[1,0,1] neg_lo:[1,0,0]
    v_cvt_pk_f16_f32 v93, v70, -v71
    ds_write_b32 v28, v93 offset:10880
    v_cvt_pk_f16_f32 v94, v56, -v57
    ds_write_b32 v28, v94 offset:1632
    v_pk_mul_f32 v[68:69], v[70:71], v[44:45] op_sel:[0,0] op_sel_hi:[0,1]
    v_pk_fma_f32 v[68:69], v[70:71], v[44:45], v[68:69] op_sel:[1,1,0] op_sel_hi:[1,0,1] neg_lo:[1,0,0]
    v_pk_mul_f32 v[58:59], v[56:57], v[42:43] op_sel:[0,0] op_sel_hi:[0,1]
    v_pk_fma_f32 v[58:59], v[56:57], v[42:43], v[58:59] op_sel:[1,1,0] op_sel_hi:[1,0,1] neg_lo:[1,0,0]
    v_cvt_pk_f16_f32 v95, v68, -v69
    ds_write_b32 v28, v95 offset:13056
    v_cvt_pk_f16_f32 v96, v58, -v59
    ds_write_b32 v28, v96 offset:2176
    v_pk_mul_f32 v[70:71], v[68:69], v[44:45] op_sel:[0,0] op_sel_hi:[0,1]
    v_pk_fma_f32 v[70:71], v[68:69], v[44:45], v[70:71] op_sel:[1,1,0] op_sel_hi:[1,0,1] neg_lo:[1,0,0]
    v_pk_mul_f32 v[60:61], v[58:59], v[42:43] op_sel:[0,0] op_sel_hi:[0,1]
    v_pk_fma_f32 v[60:61], v[58:59], v[42:43], v[60:61] op_sel:[1,1,0] op_sel_hi:[1,0,1] neg_lo:[1,0,0]
    v_cvt_pk_f16_f32 v97, v70, -v71
    ds_write_b32 v28, v97 offset:14144
    v_cvt_pk_f16_f32 v92, v60, -v61
    ds_write_b32 v28, v92 offset:2720
    v_pk_mul_f32 v[68:69], v[70:71], v[44:45] op_sel:[0,0] op_sel_hi:[0,1]
    v_pk_fma_f32 v[68:69], v[70:71], v[44:45], v[68:69] op_sel:[1,1,0] op_sel_hi:[1,0,1] neg_lo:[1,0,0]
    v_pk_mul_f32 v[62:63], v[60:61], v[42:43] op_sel:[0,0] op_sel_hi:[0,1]
    v_pk_fma_f32 v[62:63], v[60:61], v[42:43], v[62:63] op_sel:[1,1,0] op_sel_hi:[1,0,1] neg_lo:[1,0,0]
    v_cvt_pk_f16_f32 v93, v68, -v69
    ds_write_b32 v28, v93 offset:15232
    v_cvt_pk_f16_f32 v94, v62, -v63
    ds_write_b32 v28, v94 offset:3264
    v_pk_mul_f32 v[70:71], v[68:69], v[44:45] op_sel:[0,0] op_sel_hi:[0,1]
    v_pk_fma_f32 v[70:71], v[68:69], v[44:45], v[70:71] op_sel:[1,1,0] op_sel_hi:[1,0,1] neg_lo:[1,0,0]
    v_pk_mul_f32 v[64:65], v[62:63], v[42:43] op_sel:[0,0] op_sel_hi:[0,1]
    v_pk_fma_f32 v[64:65], v[62:63], v[42:43], v[64:65] op_sel:[1,1,0] op_sel_hi:[1,0,1] neg_lo:[1,0,0]
    v_cvt_pk_f16_f32 v95, v70, -v71
    ds_write_b32 v28, v95 offset:16320
    v_cvt_pk_f16_f32 v96, v64, -v65
    ds_write_b32 v28, v96 offset:3808
    v_pk_mul_f32 v[66:67], v[64:65], v[42:43] op_sel:[0,0] op_sel_hi:[0,1]
    v_pk_fma_f32 v[66:67], v[64:65], v[42:43], v[66:67] op_sel:[1,1,0] op_sel_hi:[1,0,1] neg_lo:[1,0,0]
    v_pk_mul_f32 v[72:73], v[58:59], v[44:45] op_sel:[0,0] op_sel_hi:[0,1]
    v_pk_fma_f32 v[72:73], v[58:59], v[44:45], v[72:73] op_sel:[1,1,0] op_sel_hi:[1,0,1] neg_lo:[1,0,0]
    v_pk_mul_f32 v[80:81], v[54:55], v[44:45] op_sel:[0,0] op_sel_hi:[0,1]
    v_pk_fma_f32 v[80:81], v[54:55], v[44:45], v[80:81] op_sel:[1,1,0] op_sel_hi:[1,0,1] neg_lo:[1,0,0]
    v_pk_mul_f32 v[82:83], v[62:63], v[44:45] op_sel:[0,0] op_sel_hi:[0,1]
    v_pk_fma_f32 v[82:83], v[62:63], v[44:45], v[82:83] op_sel:[1,1,0] op_sel_hi:[1,0,1] neg_lo:[1,0,0]
    v_cvt_pk_f16_f32 v97, v72, -v73
    ds_write_b32 v28, v97 offset:5440
    ds_write_b32 v28, v97 offset:6528
    v_pk_mul_f32 v[76:77], v[66:67], v[44:45] op_sel:[0,0] op_sel_hi:[0,1]
    v_pk_fma_f32 v[76:77], v[66:67], v[44:45], v[76:77] op_sel:[1,1,0] op_sel_hi:[1,0,1] neg_lo:[1,0,0]
    v_cvt_pk_f16_f32 v92, v80, -v81
    ds_write_b32 v28, v92 offset:4896
    v_cvt_pk_f16_f32 v93, v82, -v83
    ds_write_b32 v28, v93 offset:7072
    v_pk_mul_f32 v[74:75], v[72:73], v[44:45] op_sel:[0,0] op_sel_hi:[0,1]
    v_pk_fma_f32 v[74:75], v[72:73], v[44:45], v[74:75] op_sel:[1,1,0] op_sel_hi:[1,0,1] neg_lo:[1,0,0]
    v_cvt_pk_f16_f32 v94, v76, -v77
    ds_write_b32 v28, v94 offset:7616
    v_cvt_pk_f16_f32 v95, v74, -v75
    ds_write_b32 v28, v95 offset:9248
    v_pk_mul_f32 v[78:79], v[76:77], v[44:45] op_sel:[0,0] op_sel_hi:[0,1]
    v_pk_fma_f32 v[78:79], v[76:77], v[44:45], v[78:79] op_sel:[1,1,0] op_sel_hi:[1,0,1] neg_lo:[1,0,0]
    v_pk_mul_f32 v[72:73], v[74:75], v[44:45] op_sel:[0,0] op_sel_hi:[0,1]
    v_pk_fma_f32 v[72:73], v[74:75], v[44:45], v[72:73] op_sel:[1,1,0] op_sel_hi:[1,0,1] neg_lo:[1,0,0]
    v_cvt_pk_f16_f32 v96, v78, -v79
    ds_write_b32 v28, v96 offset:9792
    v_cvt_pk_f16_f32 v97, v72, -v73
    ds_write_b32 v28, v97 offset:11424
    v_pk_mul_f32 v[76:77], v[78:79], v[44:45] op_sel:[0,0] op_sel_hi:[0,1]
    v_pk_fma_f32 v[76:77], v[78:79], v[44:45], v[76:77] op_sel:[1,1,0] op_sel_hi:[1,0,1] neg_lo:[1,0,0]
    v_cvt_pk_f16_f32 v92, v76, -v77
    ds_write_b32 v28, v92 offset:11968
    v_pk_mul_f32 v[78:79], v[76:77], v[44:45] op_sel:[0,0] op_sel_hi:[0,1]
    v_pk_fma_f32 v[78:79], v[76:77], v[44:45], v[78:79] op_sel:[1,1,0] op_sel_hi:[1,0,1] neg_lo:[1,0,0]
    v_cvt_pk_f16_f32 v93, v78, -v79
    ds_write_b32 v28, v93 offset:13600
    v_pk_mul_f32 v[76:77], v[78:79], v[44:45] op_sel:[0,0] op_sel_hi:[0,1]
    v_pk_fma_f32 v[76:77], v[78:79], v[44:45], v[76:77] op_sel:[1,1,0] op_sel_hi:[1,0,1] neg_lo:[1,0,0]
    v_cvt_pk_f16_f32 v94, v76, -v77
    ds_write_b32 v28, v94 offset:14688
    v_pk_mul_f32 v[78:79], v[76:77], v[44:45] op_sel:[0,0] op_sel_hi:[0,1]
    v_pk_fma_f32 v[78:79], v[76:77], v[44:45], v[78:79] op_sel:[1,1,0] op_sel_hi:[1,0,1] neg_lo:[1,0,0]
    v_cvt_pk_f16_f32 v95, v78, -v79
    ds_write_b32 v28, v95 offset:15776
    v_pk_mul_f32 v[76:77], v[78:79], v[44:45] op_sel:[0,0] op_sel_hi:[0,1]
    v_pk_fma_f32 v[76:77], v[78:79], v[44:45], v[76:77] op_sel:[1,1,0] op_sel_hi:[1,0,1] neg_lo:[1,0,0]
    v_cvt_pk_f16_f32 v96, v76, -v77
    ds_write_b32 v28, v96 offset:16864
    s_waitcnt lgkmcnt(0)
    s_barrier
    s_sub_u32 s7, s3, 8
    v_and_b32 v8, 15, v1
    v_lshrrev_b32 v9, 4, v1
    s_mov_b32 s12, 0x05040100
    s_mov_b32 s13, 0x07060302
    v_mov_b32 v4, 0
    v_mov_b32 v6, 0
    v_mov_b32 v7, 0
    v_mov_b32 v11, 0
    v_mov_b32 v13, 0
    v_mov_b32 v25, 0
    s_mov_b64 s[54:55], s[38:39]
    v_lshlrev_b32 v56, 4, v1
    v_add_u32 v56, 16384, v56
    v_mov_b32 v52, 124480
    ds_read_b32 v52, v52
    s_waitcnt lgkmcnt(0)
    v_readfirstlane_b32 s10, v52
    s_cmp_ge_u32 s6, 18
    s_cbranch_scc1 L_MSYNC
    s_cmp_ge_u32 s6, 14
    s_cbranch_scc1 L_DPRE
    s_mul_i32 s11, s5, 7
    s_lshr_b32 s14, s6, 1
    s_add_u32 s11, s11, s14
    s_and_b32 s15, s6, 1
    s_cmp_eq_u32 s15, 0
    s_cselect_b32 s54, s38, s40
    s_cselect_b32 s55, s39, s41
    v_lshrrev_b32 v10, 2, v8
    v_lshlrev_b32 v4, 5, v10
    v_lshl_add_u32 v4, v9, 3, v4
    s_lshl_b32 s14, s7, 7
    v_add_u32 v4, s14, v4
    v_mul_u32_u24 v4, 3584, v4
    v_and_b32 v5, 3, v1
    v_lshl_add_u32 v4, v5, 4, v4
    s_lshl_b32 s14, s11, 6
    v_add_u32 v4, s14, v4
    v_add_u32 v6, 7168, v4
    v_add_u32 v7, 14336, v4
    v_add_u32 v11, 21504, v4
    v_and_b32 v13, 31, v1
    v_lshlrev_b32 v13, 3, v13
    s_lshl_b32 s14, s7, 8
    v_add_u32 v13, s14, v13
    v_lshrrev_b32 v19, 5, v1
    v_lshl_add_u32 v22, v19, 10, v13
    v_add_u32 v22, 112128, v22
    v_and_b32 v19, 1, v1
    v_lshlrev_b32 v19, 10, v19
    v_lshl_add_u32 v19, v9, 4, v19
    v_lshl_add_u32 v19, v10, 6, v19
    s_add_u32 s14, s14, 112128
    v_add_u32 v19, s14, v19
    v_cmp_eq_u32 s[60:61], v9, v10
    s_lshl_b32 s14, s7, 10
    s_add_u32 s14, s14, 120320
    v_lshl_add_u32 v24, v10, 8, s14
    v_lshl_add_u32 v24, v5, 5, v24
    v_lshlrev_b32 v23, 2, v1
    v_add_u32 v23, 120320, v23
    v_lshrrev_b32 v25, 2, v1
    v_lshlrev_b32 v25, 4, v25
    s_lshl_b32 s14, s11, 8
    s_mul_i32 s59, s15, 14336
    s_add_u32 s14, s14, s59
    s_add_u32 s14, s14, 32768
    v_add_u32 v25, s14, v25
    s_branch L_MSYNC
L_DPRE:
    s_lshl_b32 s11, s5, 2
    s_add_u32 s11, s11, s6
    s_sub_u32 s11, s11, 14
    v_lshrrev_b32 v10, 1, v8
    v_lshlrev_b32 v4, 5, v10
    v_lshl_add_u32 v4, v9, 3, v4
    s_lshl_b32 s14, s7, 8
    v_add_u32 v4, s14, v4
    v_lshlrev_b32 v4, 10, v4
    v_and_b32 v5, 1, v1
    v_lshl_add_u32 v4, v5, 4, v4
    s_lshl_b32 s14, s11, 5
    v_add_u32 v4, s14, v4
    v_add_u32 v5, 0x1000, v4
    s_cmp_eq_u32 s7, 3
    s_cselect_b32 s15, 0, 1048576
    v_add_u32 v6, s15, v4
    v_add_u32 v7, s15, v5
    s_waitcnt lgkmcnt(0)
L_MSYNC:
    s_cmp_eq_u32 s7, 0
    s_cbranch_scc0 L_NORG
    v_mov_b32 v58, 124528
    s_mov_b32 s62, 0
LW_GK1:
    ds_read_b32 v59, v58
    s_add_u32 s62, s62, 1
    s_waitcnt lgkmcnt(0)
    v_readfirstlane_b32 s63, v59
    s_cmp_ge_u32 s63, 2
    s_cbranch_scc1 LWD_GK1
    s_sleep 1
    s_cmp_lt_u32 s62, 262144
    s_cbranch_scc1 LW_GK1
LWD_GK1:
    global_load_dwordx4 v[32:35], v56, s[48:49] offset:0 sc0 sc1
    global_load_dwordx4 v[36:39], v56, s[48:49] offset:1024 sc0 sc1
    global_load_dwordx4 v[40:43], v56, s[48:49] offset:2048 sc0 sc1
    global_load_dwordx4 v[44:47], v56, s[48:49] offset:3072 sc0 sc1
L_NORG:
    v_mov_b32 v58, 124528
    s_mov_b32 s62, 0
LW_GK:
    ds_read_b32 v59, v58
    s_add_u32 s62, s62, 1
    s_waitcnt lgkmcnt(0)
    v_readfirstlane_b32 s63, v59
    s_cmp_ge_u32 s63, 8
    s_cbranch_scc1 LWD_GK
    s_sleep 1
    s_cmp_lt_u32 s62, 262144
    s_cbranch_scc1 LW_GK
LWD_GK:
    global_load_dwordx4 v[160:163], v108, s[42:43]
    global_load_dwordx4 v[164:167], v109, s[42:43]
    s_barrier
    s_cmp_eq_u32 s7, 0
    s_cbranch_scc0 L_NOKEY
    s_mov_b32 s62, 0
    s_setprio 3
    s_waitcnt vmcnt(2)
    s_branch L_RC
L_RP:
    global_load_dwordx4 v[32:35], v56, s[48:49] offset:0 sc0 sc1
    global_load_dwordx4 v[36:39], v56, s[48:49] offset:1024 sc0 sc1
    global_load_dwordx4 v[40:43], v56, s[48:49] offset:2048 sc0 sc1
    global_load_dwordx4 v[44:47], v56, s[48:49] offset:3072 sc0 sc1
    s_mov_b64 exec, -1
    s_waitcnt vmcnt(0)
L_RC:
    v_xor_b32 v48, s10, v35
    v_xor_b32 v49, s10, v39
    v_xor_b32 v50, s10, v43
    v_xor_b32 v51, s10, v47
    v_or3_b32 v48, v48, v49, v50
    v_or_b32 v48, v48, v51
    v_cmp_ne_u32 vcc, 0, v48
    s_cbranch_vccz L_RO
    s_add_u32 s62, s62, 1
    s_cmp_ge_u32 s62, 262144
    s_cbranch_scc1 L_RO
    s_sleep 3
    s_mov_b64 exec, vcc
    s_branch L_RP
L_RO:
    v_min_u32 v48, v32, v36
    v_min_u32 v49, v40, v44
    v_max_u32 v32, v32, v36
    v_max_u32 v40, v40, v44
    v_max3_u32 v33, v33, v37, v48
    v_max3_u32 v41, v41, v45, v49
    v_min_u32 v48, v32, v40
    v_max_u32 v34, v32, v40
    v_max_u32 v32, v32, v40
    v_max3_u32 v33, v33, v41, v48
    v_max_u32_dpp v34, v34, v34 quad_perm:[1,0,3,2] row_mask:0xf bank_mask:0xf
    s_nop 1
    v_max_u32_dpp v34, v34, v34 quad_perm:[2,3,0,1] row_mask:0xf bank_mask:0xf
    s_nop 1
    v_max_u32_dpp v34, v34, v34 row_half_mirror row_mask:0xf bank_mask:0xf
    s_nop 1
    v_max_u32_dpp v34, v34, v34 row_mirror row_mask:0xf bank_mask:0xf
    s_nop 1
    v_max_u32_dpp v34, v34, v34 row_bcast:15 row_mask:0xa bank_mask:0xf
    s_nop 1
    v_max_u32_dpp v34, v34, v34 row_bcast:31 row_mask:0xc bank_mask:0xf
    s_nop 0
    v_readlane_b32 s50, v34, 63
    s_nop 1
    v_cmp_eq_u32 vcc, s50, v32
    s_nop 1
    v_cndmask_b32 v34, v32, v33, vcc
    s_nop 1
    v_max_u32_dpp v34, v34, v34 quad_perm:[1,0,3,2] row_mask:0xf bank_mask:0xf
    s_nop 1
    v_max_u32_dpp v34, v34, v34 quad_perm:[2,3,0,1] row_mask:0xf bank_mask:0xf
    s_nop 1
    v_max_u32_dpp v34, v34, v34 row_half_mirror row_mask:0xf bank_mask:0xf
    s_nop 1
    v_max_u32_dpp v34, v34, v34 row_mirror row_mask:0xf bank_mask:0xf
    s_nop 1
    v_max_u32_dpp v34, v34, v34 row_bcast:15 row_mask:0xa bank_mask:0xf
    s_nop 1
    v_max_u32_dpp v34, v34, v34 row_bcast:31 row_mask:0xc bank_mask:0xf
    s_nop 0
    v_readlane_b32 s51, v34, 63
    s_and_b32 s8, s50, 0x7ff
    s_sub_u32 s8, 0x7ff, s8
    s_and_b32 s9, s51, 0x7ff
    s_sub_u32 s9, 0x7ff, s9
    v_mov_b32 v32, s8
    v_mov_b32 v33, s9
    v_mov_b32 v34, s50
    v_mov_b32 v35, s51
    v_mov_b32 v36, 124504
    ds_write_b64 v36, v[32:33]
    v_mov_b32 v36, 124448
    ds_write_b64 v36, v[34:35]
    s_setprio 0
    v_mov_b32 v37, 124536
    v_mov_b32 v38, 1
    s_mov_b64 exec, 1
    ds_add_u32 v37, v38
    s_mov_b64 exec, -1
L_NOKEY:
    s_waitcnt lgkmcnt(0)
    s_barrier
    s_cmp_ge_u32 s6, 18
    s_cbranch_scc1 L_NOMOE
    v_mov_b32 v32, 124448
    ds_read_b64 v[34:35], v32
    s_waitcnt lgkmcnt(0)
    v_readfirstlane_b32 s50, v34
    v_readfirstlane_b32 s51, v35
    s_and_b32 s8, s50, 0x7ff
    s_sub_u32 s8, 0x7ff, s8
    s_and_b32 s9, s51, 0x7ff
    s_sub_u32 s9, 0x7ff, s9
    s_cmp_ge_u32 s6, 14
    s_cbranch_scc1 L_DOWN
    s_setprio 3
    s_mov_b32 s52, 0
    s_mov_b32 s53, -1
    v_mov_b32 v12, s8
    v_mov_b32 v14, s9
    v_cndmask_b32 v12, v12, v14, s[52:53]
    v_lshl_add_u32 v14, v12, 10, v13
    global_load_dwordx2 v[16:17], v14, s[16:17]
    v_lshlrev_b32 v15, 3, v12
    global_load_dwordx2 v[30:31], v15, s[48:49] sc0 sc1
    global_load_dwordx4 v[112:115], v4, s[54:55]
    global_load_dwordx4 v[116:119], v4, s[54:55] offset:3584
    global_load_dwordx4 v[120:123], v6, s[54:55]
    global_load_dwordx4 v[124:127], v6, s[54:55] offset:3584
    global_load_dwordx4 v[128:131], v7, s[54:55]
    global_load_dwordx4 v[132:135], v7, s[54:55] offset:3584
    global_load_dwordx4 v[136:139], v11, s[54:55]
    global_load_dwordx4 v[140:143], v11, s[54:55] offset:3584
    s_waitcnt vmcnt(8)
    v_mov_b32 v18, v30
    v_and_b32 v20, 0xffff0000, v18
    v_rcp_f32 v20, v20
    v_lshlrev_b32 v21, 16, v18
    v_lshlrev_b32 v26, 16, v16
    v_and_b32 v27, 0xffff0000, v16
    v_lshlrev_b32 v28, 16, v17
    v_and_b32 v29, 0xffff0000, v17
    v_sub_f32 v26, v26, v21
    v_sub_f32 v27, v27, v21
    v_sub_f32 v28, v28, v21
    v_sub_f32 v29, v29, v21
    v_cvt_pk_bf16_f32 v16, v26, v27
    v_cvt_pk_bf16_f32 v17, v28, v29
    v_lshlrev_b32 v26, 16, v16
    v_and_b32 v27, 0xffff0000, v16
    v_lshlrev_b32 v28, 16, v17
    v_and_b32 v29, 0xffff0000, v17
    v_mul_f32 v26, v26, v20
    v_mul_f32 v27, v27, v20
    v_mul_f32 v28, v28, v20
    v_mul_f32 v29, v29, v20
    v_cvt_pk_bf16_f32 v16, v26, v27
    v_cvt_pk_bf16_f32 v17, v28, v29
    ds_write_b64 v22, v[16:17]
    ds_read_b128 v[28:31], v19
    s_waitcnt lgkmcnt(0)
    s_waitcnt vmcnt(0)
    v_perm_b32 v64, v116, v112, s12
    v_perm_b32 v65, v124, v120, s12
    v_perm_b32 v66, v132, v128, s12
    v_perm_b32 v67, v140, v136, s12
    v_perm_b32 v68, v116, v112, s13
    v_perm_b32 v69, v124, v120, s13
    v_perm_b32 v70, v132, v128, s13
    v_perm_b32 v71, v140, v136, s13
    v_perm_b32 v72, v117, v113, s12
    v_perm_b32 v73, v125, v121, s12
    v_perm_b32 v74, v133, v129, s12
    v_perm_b32 v75, v141, v137, s12
    v_perm_b32 v76, v117, v113, s13
    v_perm_b32 v77, v125, v121, s13
    v_perm_b32 v78, v133, v129, s13
    v_perm_b32 v79, v141, v137, s13
    v_perm_b32 v80, v118, v114, s12
    v_perm_b32 v81, v126, v122, s12
    v_perm_b32 v82, v134, v130, s12
    v_perm_b32 v83, v142, v138, s12
    v_perm_b32 v84, v118, v114, s13
    v_perm_b32 v85, v126, v122, s13
    v_perm_b32 v86, v134, v130, s13
    v_perm_b32 v87, v142, v138, s13
    v_perm_b32 v88, v119, v115, s12
    v_perm_b32 v89, v127, v123, s12
    v_perm_b32 v90, v135, v131, s12
    v_perm_b32 v91, v143, v139, s12
    v_perm_b32 v92, v119, v115, s13
    v_perm_b32 v93, v127, v123, s13
    v_perm_b32 v94, v135, v131, s13
    v_perm_b32 v95, v143, v139, s13
    v_mfma_f32_16x16x32_bf16 v[32:35], v[28:31], v[64:67], 0
    v_mfma_f32_16x16x32_bf16 v[36:39], v[28:31], v[68:71], 0
    v_mfma_f32_16x16x32_bf16 v[40:43], v[28:31], v[72:75], 0
    v_mfma_f32_16x16x32_bf16 v[44:47], v[28:31], v[76:79], 0
    v_mfma_f32_16x16x32_bf16 v[48:51], v[28:31], v[80:83], 0
    v_mfma_f32_16x16x32_bf16 v[52:55], v[28:31], v[84:87], 0
    v_mfma_f32_16x16x32_bf16 v[56:59], v[28:31], v[88:91], 0
    v_mfma_f32_16x16x32_bf16 v[60:63], v[28:31], v[92:95], 0
    s_mov_b64 exec, s[60:61]
    ds_write2_b32 v24, v32, v33 offset0:0 offset1:32
    ds_write2_b32 v24, v36, v37 offset0:1 offset1:33
    ds_write2_b32 v24, v40, v41 offset0:2 offset1:34
    ds_write2_b32 v24, v44, v45 offset0:3 offset1:35
    ds_write2_b32 v24, v48, v49 offset0:4 offset1:36
    ds_write2_b32 v24, v52, v53 offset0:5 offset1:37
    ds_write2_b32 v24, v56, v57 offset0:6 offset1:38
    ds_write2_b32 v24, v60, v61 offset0:7 offset1:39
    s_mov_b64 exec, -1
    v_mov_b32 v12, 124520
    v_mov_b32 v13, 1
    s_mov_b64 exec, 1
    ds_add_u32 v12, v13
    s_mov_b64 exec, -1
    s_cmp_eq_u32 s7, 0
    s_cbranch_scc0 L_MFIN
    v_mov_b32 v12, 124520
    s_mov_b32 s62, 0
LW_G:
    ds_read_b32 v13, v12
    s_add_u32 s62, s62, 1
    s_waitcnt lgkmcnt(0)
    v_readfirstlane_b32 s63, v13
    s_cmp_ge_u32 s63, 4
    s_cbranch_scc1 LWD_G
    s_cmp_lt_u32 s62, 262144
    s_cbranch_scc1 LW_G
LWD_G:
    ds_read_b32 v32, v23 offset:0
    ds_read_b32 v33, v23 offset:256
    ds_read_b32 v34, v23 offset:512
    ds_read_b32 v35, v23 offset:768
    ds_read_b32 v36, v23 offset:1024
    ds_read_b32 v37, v23 offset:1280
    ds_read_b32 v38, v23 offset:1536
    ds_read_b32 v39, v23 offset:1792
    ds_read_b32 v40, v23 offset:2048
    ds_read_b32 v41, v23 offset:2304
    ds_read_b32 v42, v23 offset:2560
    ds_read_b32 v43, v23 offset:2816
    ds_read_b32 v44, v23 offset:3072
    ds_read_b32 v45, v23 offset:3328
    ds_read_b32 v46, v23 offset:3584
    ds_read_b32 v47, v23 offset:3840
    v_mov_b32 v58, s10
    v_mov_b32 v59, s10
    s_waitcnt lgkmcnt(0)
    v_add_f32 v32, v32, v33
    v_add_f32 v34, v34, v35
    v_add_f32 v36, v36, v37
    v_add_f32 v38, v38, v39
    v_add_f32 v40, v40, v41
    v_add_f32 v42, v42, v43
    v_add_f32 v44, v44, v45
    v_add_f32 v46, v46, v47
    v_add_f32 v32, v32, v34
    v_add_f32 v36, v36, v38
    v_add_f32 v40, v40, v42
    v_add_f32 v44, v44, v46
    v_add_f32 v32, v32, v36
    v_add_f32 v40, v40, v44
    v_add_f32 v32, v32, v40
    v_cvt_pk_bf16_f32 v32, v32, v32
    s_cmp_eq_u32 s15, 0
    s_cbranch_scc0 L_NOSILU
    v_lshlrev_b32 v32, 16, v32
    v_mul_f32 v33, 0xbfb8aa3b, v32
    v_exp_f32 v33, v33
    s_nop 0
    v_add_f32 v33, 1.0, v33
    v_rcp_f32 v33, v33
    s_nop 0
    v_mul_f32 v32, v32, v33
    v_cvt_pk_bf16_f32 v32, v32, v32
L_NOSILU:
    v_and_b32 v32, 0xffff, v32
    s_nop 1
    v_mov_b32_dpp v33, v32 quad_perm:[1,1,1,1] row_mask:0xf bank_mask:0xf
    v_mov_b32_dpp v34, v32 quad_perm:[2,2,2,2] row_mask:0xf bank_mask:0xf
    v_mov_b32_dpp v35, v32 quad_perm:[3,3,3,3] row_mask:0xf bank_mask:0xf
    v_lshl_or_b32 v56, v33, 16, v32
    v_lshl_or_b32 v57, v35, 16, v34
    s_mov_b32 exec_lo, 0x11111111
    s_mov_b32 exec_hi, 0x11111111
    global_store_dwordx4 v25, v[56:59], s[48:49] sc0 sc1
    s_mov_b64 exec, -1
L_MFIN:
    s_endpgm
L_DOWN:
    s_waitcnt vmcnt(0)
    global_load_dwordx4 v[32:35], v4, s[42:43] offset:0
    global_load_dwordx4 v[36:39], v4, s[42:43] offset:1024
    global_load_dwordx4 v[40:43], v4, s[42:43] offset:2048
    global_load_dwordx4 v[44:47], v4, s[42:43] offset:3072
    global_load_dwordx4 v[48:51], v5, s[42:43] offset:0
    global_load_dwordx4 v[52:55], v5, s[42:43] offset:1024
    global_load_dwordx4 v[56:59], v5, s[42:43] offset:2048
    global_load_dwordx4 v[60:63], v5, s[42:43] offset:3072
    global_load_dwordx4 v[64:67], v6, s[42:43] offset:0
    global_load_dwordx4 v[68:71], v6, s[42:43] offset:1024
    global_load_dwordx4 v[72:75], v6, s[42:43] offset:2048
    global_load_dwordx4 v[76:79], v6, s[42:43] offset:3072
    global_load_dwordx4 v[80:83], v7, s[42:43] offset:0
    global_load_dwordx4 v[84:87], v7, s[42:43] offset:1024
    global_load_dwordx4 v[88:91], v7, s[42:43] offset:2048
    global_load_dwordx4 v[92:95], v7, s[42:43] offset:3072
    s_waitcnt vmcnt(8)
    v_perm_b32 v96, v36, v32, s12
    v_perm_b32 v97, v44, v40, s12
    v_perm_b32 v98, v52, v48, s12
    v_perm_b32 v99, v60, v56, s12
    v_perm_b32 v100, v36, v32, s13
    v_perm_b32 v101, v44, v40, s13
    v_perm_b32 v102, v52, v48, s13
    v_perm_b32 v103, v60, v56, s13
    v_perm_b32 v104, v37, v33, s12
    v_perm_b32 v105, v45, v41, s12
    v_perm_b32 v106, v53, v49, s12
    v_perm_b32 v107, v61, v57, s12
    v_perm_b32 v108, v37, v33, s13
    v_perm_b32 v109, v45, v41, s13
    v_perm_b32 v110, v53, v49, s13
    v_perm_b32 v111, v61, v57, s13
    v_perm_b32 v112, v38, v34, s12
    v_perm_b32 v113, v46, v42, s12
    v_perm_b32 v114, v54, v50, s12
    v_perm_b32 v115, v62, v58, s12
    v_perm_b32 v116, v38, v34, s13
    v_perm_b32 v117, v46, v42, s13
    v_perm_b32 v118, v54, v50, s13
    v_perm_b32 v119, v62, v58, s13
    v_perm_b32 v120, v39, v35, s12
    v_perm_b32 v121, v47, v43, s12
    v_perm_b32 v122, v55, v51, s12
    v_perm_b32 v123, v63, v59, s12
    v_perm_b32 v124, v39, v35, s13
    v_perm_b32 v125, v47, v43, s13
    v_perm_b32 v126, v55, v51, s13
    v_perm_b32 v127, v63, v59, s13
    s_waitcnt vmcnt(0)
    v_perm_b32 v32, v68, v64, s12
    v_perm_b32 v33, v76, v72, s12
    v_perm_b32 v34, v84, v80, s12
    v_perm_b32 v35, v92, v88, s12
    v_perm_b32 v36, v68, v64, s13
    v_perm_b32 v37, v76, v72, s13
    v_perm_b32 v38, v84, v80, s13
    v_perm_b32 v39, v92, v88, s13
    v_perm_b32 v40, v69, v65, s12
    v_perm_b32 v41, v77, v73, s12
    v_perm_b32 v42, v85, v81, s12
    v_perm_b32 v43, v93, v89, s12
    v_perm_b32 v44, v69, v65, s13
    v_perm_b32 v45, v77, v73, s13
    v_perm_b32 v46, v85, v81, s13
    v_perm_b32 v47, v93, v89, s13
    v_perm_b32 v48, v70, v66, s12
    v_perm_b32 v49, v78, v74, s12
    v_perm_b32 v50, v86, v82, s12
    v_perm_b32 v51, v94, v90, s12
    v_perm_b32 v52, v70, v66, s13
    v_perm_b32 v53, v78, v74, s13
    v_perm_b32 v54, v86, v82, s13
    v_perm_b32 v55, v94, v90, s13
    v_perm_b32 v56, v71, v67, s12
    v_perm_b32 v57, v79, v75, s12
    v_perm_b32 v58, v87, v83, s12
    v_perm_b32 v59, v95, v91, s12
    v_perm_b32 v60, v71, v67, s13
    v_perm_b32 v61, v79, v75, s13
    v_perm_b32 v62, v87, v83, s13
    v_perm_b32 v63, v95, v91, s13
    s_lshl_b32 s14, s7, 11
    s_add_u32 s14, s14, 32768
    v_lshl_add_u32 v12, v1, 4, s14
    s_cmp_eq_u32 s7, 3
    s_cselect_b32 s15, 0, 0x2000
    v_add_u32 v13, s15, v12
    s_mov_b32 s62, 0
    s_lshl_b32 s14, s7, 11
    s_add_u32 s14, s14, 112128
    v_lshrrev_b32 v24, 4, v1
    v_lshlrev_b32 v24, 6, v24
    v_and_b32 v25, 7, v1
    v_lshl_add_u32 v24, v25, 3, v24
    v_bfe_u32 v25, v1, 3, 1
    v_lshl_add_u32 v24, v25, 9, v24
    v_add_u32 v24, s14, v24
    v_add_u32 v14, 14336, v12
    v_add_u32 v15, 14336, v13
    v_and_b32 v25, 1, v1
    v_lshlrev_b32 v25, 9, v25
    v_lshl_add_u32 v25, v10, 6, v25
    v_lshl_add_u32 v25, v9, 4, v25
    v_add_u32 v25, s14, v25
    v_lshrrev_b32 v26, 1, v10
    v_cmp_eq_u32 s[56:57], v9, v26
    v_and_b32 v26, 1, v10
    v_cmp_eq_u32 s[60:61], 1, v26
    s_lshl_b32 s14, s7, 10
    s_add_u32 s14, s14, 120320
    v_lshl_add_u32 v160, v10, 7, s14
    v_and_b32 v26, 1, v1
    v_lshl_add_u32 v160, v26, 5, v160
    v_bfe_u32 v28, v1, 4, 1
    v_bfe_u32 v27, v1, 1, 3
    s_lshl_b32 s14, s11, 3
    v_add_u32 v26, s14, v27
    v_lshlrev_b32 v161, 4, v26
    v_lshl_add_u32 v161, v28, 12, v161
    v_add_u32 v161, 65536, v161
    v_cmp_eq_u32 vcc, 1, v28
    v_mov_b32 v30, s50
    v_mov_b32 v31, s51
    v_cndmask_b32 v30, v30, v31, vcc
    v_mov_b32 v163, s8
    v_mov_b32 v31, s9
    v_cndmask_b32 v163, v163, v31, vcc
    v_lshrrev_b32 v30, 16, v30
    v_bfe_i32 v31, v30, 15, 1
    v_not_b32 v31, v31
    v_or_b32 v31, 0x8000, v31
    v_xor_b32 v30, v30, v31
    v_lshlrev_b32 v30, 16, v30
    v_mul_f32 v30, 0xbfb8aa3b, v30
    v_exp_f32 v30, v30
    s_nop 0
    v_add_f32 v30, 1.0, v30
    v_rcp_f32 v30, v30
    s_nop 0
    v_cvt_pk_bf16_f32 v30, v30, v30
    v_lshlrev_b32 v162, 16, v30
    v_lshlrev_b32 v163, 10, v163
    v_lshl_add_u32 v163, v26, 2, v163
    v_and_b32 v164, 31, v1
    v_lshlrev_b32 v164, 2, v164
    v_lshrrev_b32 v31, 5, v1
    v_lshl_add_u32 v164, v31, 11, v164
    v_add_u32 v164, 120320, v164
    v_mov_b32 v26, 124588
    s_mov_b32 s62, 0
LW_HC:
    ds_read_b32 v27, v26
    s_add_u32 s62, s62, 1
    s_waitcnt lgkmcnt(0)
    v_readfirstlane_b32 s63, v27
    s_cmp_ge_u32 s63, 4
    s_cbranch_scc1 LWD_HC
    s_sleep 2
    s_cmp_lt_u32 s62, 262144
    s_cbranch_scc1 LW_HC
LWD_HC:
    s_mov_b32 s62, 0
L_HPOLL:
    global_load_dwordx4 v[64:67], v12, s[48:49] sc0 sc1
    global_load_dwordx4 v[68:71], v12, s[48:49] offset:1024 sc0 sc1
    global_load_dwordx4 v[72:75], v13, s[48:49] sc0 sc1
    global_load_dwordx4 v[76:79], v13, s[48:49] offset:1024 sc0 sc1
    global_load_dwordx4 v[80:83], v14, s[48:49] sc0 sc1
    global_load_dwordx4 v[84:87], v14, s[48:49] offset:1024 sc0 sc1
    global_load_dwordx4 v[88:91], v15, s[48:49] sc0 sc1
    global_load_dwordx4 v[92:95], v15, s[48:49] offset:1024 sc0 sc1
    s_mov_b64 exec, -1
    s_waitcnt vmcnt(0)
    v_xor_b32 v16, s10, v67
    v_xor_b32 v17, s10, v71
    v_xor_b32 v18, s10, v75
    v_xor_b32 v19, s10, v79
    v_xor_b32 v20, s10, v83
    v_xor_b32 v21, s10, v87
    v_xor_b32 v22, s10, v91
    v_xor_b32 v23, s10, v95
    v_or3_b32 v16, v16, v17, v18
    v_or3_b32 v19, v19, v20, v21
    v_or3_b32 v16, v16, v22, v23
    v_or_b32 v16, v16, v19
    v_cmp_ne_u32 vcc, 0, v16
    s_cbranch_vccz L_HOK
    s_sleep 3
    s_add_u32 s62, s62, 1
    s_mov_b64 exec, vcc
    s_cmp_lt_u32 s62, 262144
    s_cbranch_scc1 L_HPOLL
    s_mov_b64 exec, -1
L_HOK:
    s_setprio 3
    v_lshlrev_b32 v128, 16, v64
    v_and_b32 v129, 0xffff0000, v64
    v_lshlrev_b32 v130, 16, v80
    v_and_b32 v131, 0xffff0000, v80
    v_lshlrev_b32 v132, 16, v65
    v_and_b32 v133, 0xffff0000, v65
    v_lshlrev_b32 v134, 16, v81
    v_and_b32 v135, 0xffff0000, v81
    v_lshlrev_b32 v136, 16, v68
    v_and_b32 v137, 0xffff0000, v68
    v_lshlrev_b32 v138, 16, v84
    v_and_b32 v139, 0xffff0000, v84
    v_lshlrev_b32 v140, 16, v69
    v_and_b32 v141, 0xffff0000, v69
    v_lshlrev_b32 v142, 16, v85
    v_and_b32 v143, 0xffff0000, v85
    v_lshlrev_b32 v144, 16, v72
    v_and_b32 v145, 0xffff0000, v72
    v_lshlrev_b32 v146, 16, v88
    v_and_b32 v147, 0xffff0000, v88
    v_lshlrev_b32 v148, 16, v73
    v_and_b32 v149, 0xffff0000, v73
    v_lshlrev_b32 v150, 16, v89
    v_and_b32 v151, 0xffff0000, v89
    v_lshlrev_b32 v152, 16, v76
    v_and_b32 v153, 0xffff0000, v76
    v_lshlrev_b32 v154, 16, v92
    v_and_b32 v155, 0xffff0000, v92
    v_lshlrev_b32 v156, 16, v77
    v_and_b32 v157, 0xffff0000, v77
    v_lshlrev_b32 v158, 16, v93
    v_and_b32 v159, 0xffff0000, v93
    v_pk_mul_f32 v[128:129], v[128:129], v[130:131]
    v_pk_mul_f32 v[132:133], v[132:133], v[134:135]
    v_pk_mul_f32 v[136:137], v[136:137], v[138:139]
    v_pk_mul_f32 v[140:141], v[140:141], v[142:143]
    v_pk_mul_f32 v[144:145], v[144:145], v[146:147]
    v_pk_mul_f32 v[148:149], v[148:149], v[150:151]
    v_pk_mul_f32 v[152:153], v[152:153], v[154:155]
    v_pk_mul_f32 v[156:157], v[156:157], v[158:159]
    v_cvt_pk_bf16_f32 v64, v128, v129
    v_cvt_pk_bf16_f32 v65, v132, v133
    v_cvt_pk_bf16_f32 v68, v136, v137
    v_cvt_pk_bf16_f32 v69, v140, v141
    v_cvt_pk_bf16_f32 v72, v144, v145
    v_cvt_pk_bf16_f32 v73, v148, v149
    v_cvt_pk_bf16_f32 v76, v152, v153
    v_cvt_pk_bf16_f32 v77, v156, v157
    ds_write_b64 v24, v[64:65]
    ds_write_b64 v24, v[68:69] offset:256
    ds_read_b128 v[16:19], v25
    ds_write_b64 v24, v[72:73] offset:1024
    ds_write_b64 v24, v[76:77] offset:1280
    ds_read_b128 v[20:23], v25 offset:1024
    s_waitcnt lgkmcnt(3)
    v_mfma_f32_16x16x32_bf16 v[128:131], v[16:19], v[96:99], 0
    v_mfma_f32_16x16x32_bf16 v[132:135], v[16:19], v[100:103], 0
    v_mfma_f32_16x16x32_bf16 v[136:139], v[16:19], v[104:107], 0
    v_mfma_f32_16x16x32_bf16 v[140:143], v[16:19], v[108:111], 0
    v_mfma_f32_16x16x32_bf16 v[144:147], v[16:19], v[112:115], 0
    v_mfma_f32_16x16x32_bf16 v[148:151], v[16:19], v[116:119], 0
    v_mfma_f32_16x16x32_bf16 v[152:155], v[16:19], v[120:123], 0
    v_mfma_f32_16x16x32_bf16 v[156:159], v[16:19], v[124:127], 0
    s_waitcnt lgkmcnt(0)
    s_cmp_eq_u32 s7, 3
    s_cbranch_scc1 L_DSKIP
    v_mfma_f32_16x16x32_bf16 v[128:131], v[20:23], v[32:35], v[128:131]
    v_mfma_f32_16x16x32_bf16 v[132:135], v[20:23], v[36:39], v[132:135]
    v_mfma_f32_16x16x32_bf16 v[136:139], v[20:23], v[40:43], v[136:139]
    v_mfma_f32_16x16x32_bf16 v[140:143], v[20:23], v[44:47], v[140:143]
    v_mfma_f32_16x16x32_bf16 v[144:147], v[20:23], v[48:51], v[144:147]
    v_mfma_f32_16x16x32_bf16 v[148:151], v[20:23], v[52:55], v[148:151]
    v_mfma_f32_16x16x32_bf16 v[152:155], v[20:23], v[56:59], v[152:155]
    v_mfma_f32_16x16x32_bf16 v[156:159], v[20:23], v[60:63], v[156:159]
L_DSKIP:
    s_nop 7
    v_cndmask_b32 v128, v128, v130, s[60:61]
    v_cndmask_b32 v129, v129, v131, s[60:61]
    v_cndmask_b32 v132, v132, v134, s[60:61]
    v_cndmask_b32 v133, v133, v135, s[60:61]
    v_cndmask_b32 v136, v136, v138, s[60:61]
    v_cndmask_b32 v137, v137, v139, s[60:61]
    v_cndmask_b32 v140, v140, v142, s[60:61]
    v_cndmask_b32 v141, v141, v143, s[60:61]
    v_cndmask_b32 v144, v144, v146, s[60:61]
    v_cndmask_b32 v145, v145, v147, s[60:61]
    v_cndmask_b32 v148, v148, v150, s[60:61]
    v_cndmask_b32 v149, v149, v151, s[60:61]
    v_cndmask_b32 v152, v152, v154, s[60:61]
    v_cndmask_b32 v153, v153, v155, s[60:61]
    v_cndmask_b32 v156, v156, v158, s[60:61]
    v_cndmask_b32 v157, v157, v159, s[60:61]
    s_mov_b64 exec, s[56:57]
    ds_write2_b32 v160, v128, v129 offset0:0 offset1:16
    ds_write2_b32 v160, v132, v133 offset0:1 offset1:17
    ds_write2_b32 v160, v136, v137 offset0:2 offset1:18
    ds_write2_b32 v160, v140, v141 offset0:3 offset1:19
    ds_write2_b32 v160, v144, v145 offset0:4 offset1:20
    ds_write2_b32 v160, v148, v149 offset0:5 offset1:21
    ds_write2_b32 v160, v152, v153 offset0:6 offset1:22
    ds_write2_b32 v160, v156, v157 offset0:7 offset1:23
    s_mov_b64 exec, -1
    v_mov_b32 v12, 124520
    v_mov_b32 v13, 1
    s_mov_b64 exec, 1
    ds_add_u32 v12, v13
    s_mov_b64 exec, -1
    s_cmp_eq_u32 s7, 3
    s_cbranch_scc0 L_DFIN
    global_load_dwordx4 v[64:67], v161, s[48:49] sc0 sc1
    v_mov_b32 v12, 124520
    s_mov_b32 s62, 0
LW_D:
    ds_read_b32 v13, v12
    s_add_u32 s62, s62, 1
    s_waitcnt lgkmcnt(0)
    v_readfirstlane_b32 s63, v13
    s_cmp_ge_u32 s63, 4
    s_cbranch_scc1 LWD_D
    s_cmp_lt_u32 s62, 262144
    s_cbranch_scc1 LW_D
LWD_D:
    ds_read_b32 v32, v164 offset:0
    ds_read_b32 v33, v164 offset:128
    ds_read_b32 v34, v164 offset:256
    ds_read_b32 v35, v164 offset:384
    ds_read_b32 v36, v164 offset:512
    ds_read_b32 v37, v164 offset:640
    ds_read_b32 v38, v164 offset:768
    ds_read_b32 v39, v164 offset:896
    ds_read_b32 v40, v164 offset:1024
    ds_read_b32 v41, v164 offset:1152
    ds_read_b32 v42, v164 offset:1280
    ds_read_b32 v43, v164 offset:1408
    ds_read_b32 v44, v164 offset:1536
    ds_read_b32 v45, v164 offset:1664
    ds_read_b32 v46, v164 offset:1792
    ds_read_b32 v47, v164 offset:1920
    s_waitcnt lgkmcnt(0)
    v_add_f32 v32, v32, v33
    v_add_f32 v34, v34, v35
    v_add_f32 v36, v36, v37
    v_add_f32 v38, v38, v39
    v_add_f32 v40, v40, v41
    v_add_f32 v42, v42, v43
    v_add_f32 v44, v44, v45
    v_add_f32 v46, v46, v47
    v_add_f32 v32, v32, v34
    v_add_f32 v36, v36, v38
    v_add_f32 v40, v40, v42
    v_add_f32 v44, v44, v46
    v_add_f32 v32, v32, v36
    v_add_f32 v40, v40, v44
    v_add_f32 v32, v32, v40
    v_mov_b32 v33, v32
    v_mov_b32 v62, 0x3a000000
    s_mov_b32 s62, 0
    v_permlane32_swap_b32 v32, v33
    v_add_f32 v52, v32, v33
    s_nop 1
    v_mov_b32_dpp v53, v52 quad_perm:[1,1,3,3] row_mask:0xf bank_mask:0xf
    v_cvt_pk_bf16_f32 v52, v52, v53
    v_and_b32 v53, 0xffff0000, v52
    v_lshlrev_b32 v52, 16, v52
    v_mul_f32 v52, v52, v162
    v_mul_f32 v53, v53, v162
    v_cvt_pk_bf16_f32 v52, v52, v53
    v_and_b32 v53, 0xffff0000, v52
    v_lshlrev_b32 v52, 16, v52
L_TPOLL:
    s_waitcnt vmcnt(0)
    v_cmp_ne_u32 vcc, s10, v67
    s_cbranch_vccz L_TOK
    s_sleep 1
    s_add_u32 s62, s62, 1
    s_cmp_ge_u32 s62, 262144
    s_cbranch_scc1 L_TOK
    global_load_dwordx4 v[64:67], v161, s[48:49] sc0 sc1
    s_branch L_TPOLL
L_TOK:
    v_lshlrev_b32 v60, 16, v65
    v_and_b32 v61, 0xffff0000, v65
    v_fma_f32 v52, v60, v62, v52
    v_fma_f32 v53, v61, v62, v53
    v_cvt_pk_bf16_f32 v52, v52, v53
    v_and_b32 v53, 0xffff0000, v52
    v_lshlrev_b32 v52, 16, v52
    v_lshlrev_b32 v60, 16, v64
    v_and_b32 v61, 0xffff0000, v64
    v_add_f32 v52, v52, v60
    v_add_f32 v53, v53, v61
    v_cvt_pk_bf16_f32 v52, v52, v53
    s_mov_b64 exec, 0x55555555
    global_store_dword v163, v52, s[44:45] sc0 sc1
    s_mov_b64 exec, -1
L_DFIN:
    s_endpgm
L_NOMOE:
    s_waitcnt lgkmcnt(0)
    s_endpgm
L_END:
    s_endpgm
.section .rodata,"a"
.p2align 6
.amdhsa_kernel parallel_sum__ssm_conv_s4__moe_arch_mod__prompt_kernel
  .amdhsa_next_free_vgpr 168
  .amdhsa_next_free_sgpr 102
  .amdhsa_accum_offset 168
  .amdhsa_group_segment_fixed_size 0
  .amdhsa_kernarg_size 136
  .amdhsa_user_sgpr_count 2
  .amdhsa_user_sgpr_kernarg_segment_ptr 1
  .amdhsa_system_sgpr_workgroup_id_x 1
  .amdhsa_float_denorm_mode_32 3
.end_amdhsa_kernel
```
